```python
import torch

def _softmax(x, axis=-1):
    return torch.softmax(x, dim=axis)

def _gelu(x):
    return torch.nn.functional.gelu(x, approximate='tanh')

def _silu(x):
    return torch.nn.functional.silu(x)

def _sigmoid(x):
    return torch.sigmoid(x)

def _layernorm(x, axis=-1, eps=1e-05):
    m = x.mean(dim=axis, keepdim=True)
    v = x.var(dim=axis, keepdim=True, unbiased=False)
    return (x - m) / torch.sqrt(v + eps)

def _scatter_add(tgt, idx, src, axis=0):
    return tgt.clone().index_add_(axis, idx, src)

def _segment_sum(src, seg, n):
    out = torch.zeros((n,) + src.shape[1:], dtype=src.dtype)
    return out.index_add_(0, seg, src)

def _pad(x, pw):
    flat = tuple((v for pair in reversed(pw) for v in pair))
    return torch.nn.functional.pad(x, flat)
kernel_name = 'standalone__conformer_family_zipformer__speech'

def setup_inputs():

    _w = lambda a: (lambda t: t.to(torch.bfloat16) if t.is_floating_point() else t)(torch.as_tensor(a))
    B, T, D, K, H = (2, 4000, 256, 5, 4)
    sc = 0.1
    return {'x': _w((lambda *s: torch.randn(*s, dtype=torch.bfloat16) * 0.8)(B, T, D)), 'w_ff1a': _w((lambda *s: torch.randn(*s, dtype=torch.bfloat16) * 0.8)(D, 4 * D) * sc), 'w_ff1b': _w((lambda *s: torch.randn(*s, dtype=torch.bfloat16) * 0.8)(4 * D, D) * sc), 'w_qkv': _w((lambda *s: torch.randn(*s, dtype=torch.bfloat16) * 0.8)(D, 3 * D) * sc), 'w_o': _w((lambda *s: torch.randn(*s, dtype=torch.bfloat16) * 1.6)(D, D) * sc), 'w_pw1': _w((lambda *s: torch.randn(*s, dtype=torch.bfloat16) * 1.6)(D, 2 * D) * sc), 'dw': _w((lambda *s: torch.randn(*s, dtype=torch.bfloat16) * 0.4)(K, D)), 'w_pw2': _w((lambda *s: torch.randn(*s, dtype=torch.bfloat16) * 0.4)(D, D) * sc), 'w_ff2a': _w((lambda *s: torch.randn(*s, dtype=torch.bfloat16) * 0.8)(D, 4 * D) * sc), 'w_ff2b': _w((lambda *s: torch.randn(*s, dtype=torch.bfloat16) * 0.8)(4 * D, D) * sc)}

def reference(x, w_ff1a, w_ff1b, w_qkv, w_o, w_pw1, dw, w_pw2, w_ff2a, w_ff2b):
    B, T, D = x.shape
    K = dw.shape[0]
    H = 4
    Dh = D // H
    h = _layernorm(x, axis=-1)
    h = _silu(h @ w_ff1a) @ w_ff1b
    x = x + 0.5 * h
    h = _layernorm(x, axis=-1)
    qkv = h @ w_qkv
    q = (lambda x, *d: x.permute(*d))(qkv[..., :D].reshape(B, T, H, Dh), 0, 2, 1, 3)
    k = (lambda x, *d: x.permute(*d))(qkv[..., D:2 * D].reshape(B, T, H, Dh), 0, 2, 1, 3)
    v = (lambda x, *d: x.permute(*d))(qkv[..., 2 * D:].reshape(B, T, H, Dh), 0, 2, 1, 3)
    scale = Dh ** (-0.5)
    scores = torch.einsum('bhqd,bhkd->bhqk', q, k) * scale
    p = _softmax(scores, axis=-1)
    att = torch.einsum('bhqk,bhkd->bhqd', p, v)
    att = (lambda x, *d: x.permute(*d))(att, 0, 2, 1, 3).reshape(B, T, D)
    x = x + att @ w_o
    h = _layernorm(x, axis=-1)
    h = h @ w_pw1
    a, b = (h[..., :D].clone(), h[..., D:].clone())
    h = a * _sigmoid(b)
    pad = K // 2
    hp = _pad(h, ((0, 0), (pad, pad), (0, 0)))
    c = torch.zeros_like(h)
    for i in range(K):
        c = c + hp[:, i:i + T, :] * dw[i][None, None, :]
    x = x + _silu(c) @ w_pw2
    h = _layernorm(x, axis=-1)
    h = _silu(h @ w_ff2a) @ w_ff2b
    x = x + 0.5 * h
    return _layernorm(x, axis=-1)
```

```asm
; @launch kernel=k0_kernel grid=(736,1,1) block=(256,1,1) lds=0
; @launch kernel=k1_kernel grid=(250,1,1) block=(512,1,1) lds=90112
; @launch kernel=k2_kernel grid=(256,1,1) block=(512,1,1) lds=65536
; @launch kernel=k3_kernel grid=(250,1,1) block=(512,1,1) lds=90112
.amdgcn_target "amdgcn-amd-amdhsa--gfx950"
.text
.globl k0_kernel
.p2align 8
.type k0_kernel,@function
k0_kernel:
    s_load_dwordx2 s[6:7], s[0:1], 96
    v_and_b32 v1, 63, v0
    v_lshrrev_b32 v2, 6, v0
    s_nop 0
    v_readfirstlane_b32 s3, v2
    v_and_b32 v3, 31, v1
    v_lshrrev_b32 v4, 5, v1
    v_lshlrev_b32 v5, 4, v1
    s_cmp_lt_u32 s2, 128
    s_cbranch_scc1 L_k0_m0
    s_cmp_lt_u32 s2, 256
    s_cbranch_scc1 L_k0_m1
    s_cmp_lt_u32 s2, 352
    s_cbranch_scc1 L_k0_m2
    s_cmp_lt_u32 s2, 384
    s_cbranch_scc1 L_k0_m3
    s_cmp_lt_u32 s2, 448
    s_cbranch_scc1 L_k0_m4
    s_cmp_lt_u32 s2, 480
    s_cbranch_scc1 L_k0_m5
    s_cmp_lt_u32 s2, 608
    s_cbranch_scc1 L_k0_m6
    s_cmp_lt_u32 s2, 736
    s_cbranch_scc1 L_k0_m7
    s_branch L_exit_k0_kernel
L_k0_m0:
    s_load_dwordx2 s[4:5], s[0:1], 8
    s_sub_u32 s20, s2, 0
    s_lshl_b32 s20, s20, 2
    s_add_u32 s20, s20, s3
    s_and_b32 s21, s20, 15
    s_lshr_b32 s22, s20, 4
    v_lshlrev_b32 v6, 2, v4
    s_lshl_b32 s23, s21, 4
    v_add_u32 v6, s23, v6
    s_movk_i32 s24, 1024
    v_mul_lo_u32 v6, v6, s24
    s_lshl_b32 s23, s22, 5
    v_add3_u32 v6, v6, s23, v3
    v_lshlrev_b32 v6, 1, v6
    s_lshr_b32 s25, s22, 2
    s_and_b32 s26, s22, 3
    s_lshl_b32 s26, s26, 4
    s_mul_i32 s25, s25, 180224
    s_add_u32 s26, s26, s21
    s_add_u32 s26, s26, 0
    s_lshl_b32 s26, s26, 10
    s_add_u32 s25, s25, s26
    s_add_u32 s25, s25, 0
    s_waitcnt lgkmcnt(0)
    s_mov_b32 s8, s4
    s_and_b32 s9, s5, 0xffff
    s_mov_b32 s10, 524288
    s_mov_b32 s11, 0x00020000
    s_mov_b32 s12, s6
    s_and_b32 s13, s7, 0xffff
    s_mov_b32 s14, 268435456
    s_mov_b32 s15, 0x00020000
    s_mov_b32 s27, 0
    s_mov_b32 s28, 2048
    s_mov_b32 s29, 4096
    s_mov_b32 s30, 6144
    s_mov_b32 s31, 16384
    s_mov_b32 s32, 18432
    s_mov_b32 s33, 20480
    s_mov_b32 s34, 22528
    buffer_load_ushort v8, v6, s[8:11], s27 offen
    buffer_load_ushort v9, v6, s[8:11], s28 offen
    buffer_load_ushort v10, v6, s[8:11], s29 offen
    buffer_load_ushort v11, v6, s[8:11], s30 offen
    buffer_load_ushort v12, v6, s[8:11], s31 offen
    buffer_load_ushort v13, v6, s[8:11], s32 offen
    buffer_load_ushort v14, v6, s[8:11], s33 offen
    buffer_load_ushort v15, v6, s[8:11], s34 offen
    s_waitcnt vmcnt(6)
    v_lshl_or_b32 v16, v9, 16, v8
    s_waitcnt vmcnt(4)
    v_lshl_or_b32 v17, v11, 16, v10
    s_waitcnt vmcnt(2)
    v_lshl_or_b32 v18, v13, 16, v12
    s_waitcnt vmcnt(0)
    v_lshl_or_b32 v19, v15, 16, v14
    buffer_store_dwordx4 v[16:19], v5, s[12:15], s25 offen
    s_branch L_exit_k0_kernel
L_k0_m1:
    s_load_dwordx2 s[4:5], s[0:1], 16
    s_sub_u32 s20, s2, 128
    s_lshl_b32 s20, s20, 2
    s_add_u32 s20, s20, s3
    s_and_b32 s21, s20, 63
    s_lshr_b32 s22, s20, 6
    v_lshlrev_b32 v6, 2, v4
    s_lshl_b32 s23, s21, 4
    v_add_u32 v6, s23, v6
    s_movk_i32 s24, 256
    v_mul_lo_u32 v6, v6, s24
    s_lshl_b32 s23, s22, 5
    v_add3_u32 v6, v6, s23, v3
    v_lshlrev_b32 v6, 1, v6
    s_mov_b32 s25, s22
    s_mov_b32 s26, 0
    s_mul_i32 s25, s25, 180224
    s_add_u32 s26, s26, s21
    s_add_u32 s26, s26, 64
    s_lshl_b32 s26, s26, 10
    s_add_u32 s25, s25, s26
    s_add_u32 s25, s25, 0
    s_waitcnt lgkmcnt(0)
    s_mov_b32 s8, s4
    s_and_b32 s9, s5, 0xffff
    s_mov_b32 s10, 524288
    s_mov_b32 s11, 0x00020000
    s_mov_b32 s12, s6
    s_and_b32 s13, s7, 0xffff
    s_mov_b32 s14, 268435456
    s_mov_b32 s15, 0x00020000
    s_mov_b32 s27, 0
    s_mov_b32 s28, 512
    s_mov_b32 s29, 1024
    s_mov_b32 s30, 1536
    s_mov_b32 s31, 4096
    s_mov_b32 s32, 4608
    s_mov_b32 s33, 5120
    s_mov_b32 s34, 5632
    buffer_load_ushort v8, v6, s[8:11], s27 offen
    buffer_load_ushort v9, v6, s[8:11], s28 offen
    buffer_load_ushort v10, v6, s[8:11], s29 offen
    buffer_load_ushort v11, v6, s[8:11], s30 offen
    buffer_load_ushort v12, v6, s[8:11], s31 offen
    buffer_load_ushort v13, v6, s[8:11], s32 offen
    buffer_load_ushort v14, v6, s[8:11], s33 offen
    buffer_load_ushort v15, v6, s[8:11], s34 offen
    s_waitcnt vmcnt(6)
    v_lshl_or_b32 v16, v9, 16, v8
    s_waitcnt vmcnt(4)
    v_lshl_or_b32 v17, v11, 16, v10
    s_waitcnt vmcnt(2)
    v_lshl_or_b32 v18, v13, 16, v12
    s_waitcnt vmcnt(0)
    v_lshl_or_b32 v19, v15, 16, v14
    buffer_store_dwordx4 v[16:19], v5, s[12:15], s25 offen
    s_branch L_exit_k0_kernel
L_k0_m2:
    s_load_dwordx2 s[4:5], s[0:1], 24
    s_sub_u32 s20, s2, 256
    s_lshl_b32 s20, s20, 2
    s_add_u32 s20, s20, s3
    s_and_b32 s21, s20, 15
    s_lshr_b32 s22, s20, 4
    v_lshlrev_b32 v6, 2, v4
    s_lshl_b32 s23, s21, 4
    v_add_u32 v6, s23, v6
    s_movk_i32 s24, 768
    v_mul_lo_u32 v6, v6, s24
    s_lshl_b32 s23, s22, 5
    v_add3_u32 v6, v6, s23, v3
    v_lshlrev_b32 v6, 1, v6
    s_and_b32 s25, s22, 7
    s_lshr_b32 s26, s22, 3
    s_lshl_b32 s26, s26, 4
    s_mul_i32 s25, s25, 180224
    s_add_u32 s26, s26, s21
    s_add_u32 s26, s26, 128
    s_lshl_b32 s26, s26, 10
    s_add_u32 s25, s25, s26
    s_add_u32 s25, s25, 0
    s_waitcnt lgkmcnt(0)
    s_mov_b32 s8, s4
    s_and_b32 s9, s5, 0xffff
    s_mov_b32 s10, 393216
    s_mov_b32 s11, 0x00020000
    s_mov_b32 s12, s6
    s_and_b32 s13, s7, 0xffff
    s_mov_b32 s14, 268435456
    s_mov_b32 s15, 0x00020000
    s_mov_b32 s27, 0
    s_mov_b32 s28, 1536
    s_mov_b32 s29, 3072
    s_mov_b32 s30, 4608
    s_mov_b32 s31, 12288
    s_mov_b32 s32, 13824
    s_mov_b32 s33, 15360
    s_mov_b32 s34, 16896
    buffer_load_ushort v8, v6, s[8:11], s27 offen
    buffer_load_ushort v9, v6, s[8:11], s28 offen
    buffer_load_ushort v10, v6, s[8:11], s29 offen
    buffer_load_ushort v11, v6, s[8:11], s30 offen
    buffer_load_ushort v12, v6, s[8:11], s31 offen
    buffer_load_ushort v13, v6, s[8:11], s32 offen
    buffer_load_ushort v14, v6, s[8:11], s33 offen
    buffer_load_ushort v15, v6, s[8:11], s34 offen
    s_waitcnt vmcnt(6)
    v_lshl_or_b32 v16, v9, 16, v8
    s_waitcnt vmcnt(4)
    v_lshl_or_b32 v17, v11, 16, v10
    s_waitcnt vmcnt(2)
    v_lshl_or_b32 v18, v13, 16, v12
    s_waitcnt vmcnt(0)
    v_lshl_or_b32 v19, v15, 16, v14
    buffer_store_dwordx4 v[16:19], v5, s[12:15], s25 offen
    s_branch L_exit_k0_kernel
L_k0_m3:
    s_load_dwordx2 s[4:5], s[0:1], 32
    s_sub_u32 s20, s2, 352
    s_lshl_b32 s20, s20, 2
    s_add_u32 s20, s20, s3
    s_and_b32 s21, s20, 15
    s_lshr_b32 s22, s20, 4
    v_lshlrev_b32 v6, 2, v4
    s_lshl_b32 s23, s21, 4
    v_add_u32 v6, s23, v6
    s_movk_i32 s24, 256
    v_mul_lo_u32 v6, v6, s24
    s_lshl_b32 s23, s22, 5
    v_add3_u32 v6, v6, s23, v3
    v_lshlrev_b32 v6, 1, v6
    s_mov_b32 s25, s22
    s_mov_b32 s26, 0
    s_mul_i32 s25, s25, 49152
    s_add_u32 s26, s26, s21
    s_add_u32 s26, s26, 0
    s_lshl_b32 s26, s26, 10
    s_add_u32 s25, s25, s26
    s_add_u32 s25, s25, 1441792
    s_waitcnt lgkmcnt(0)
    s_mov_b32 s8, s4
    s_and_b32 s9, s5, 0xffff
    s_mov_b32 s10, 131072
    s_mov_b32 s11, 0x00020000
    s_mov_b32 s12, s6
    s_and_b32 s13, s7, 0xffff
    s_mov_b32 s14, 268435456
    s_mov_b32 s15, 0x00020000
    s_mov_b32 s27, 0
    s_mov_b32 s28, 512
    s_mov_b32 s29, 1024
    s_mov_b32 s30, 1536
    s_mov_b32 s31, 4096
    s_mov_b32 s32, 4608
    s_mov_b32 s33, 5120
    s_mov_b32 s34, 5632
    buffer_load_ushort v8, v6, s[8:11], s27 offen
    buffer_load_ushort v9, v6, s[8:11], s28 offen
    buffer_load_ushort v10, v6, s[8:11], s29 offen
    buffer_load_ushort v11, v6, s[8:11], s30 offen
    buffer_load_ushort v12, v6, s[8:11], s31 offen
    buffer_load_ushort v13, v6, s[8:11], s32 offen
    buffer_load_ushort v14, v6, s[8:11], s33 offen
    buffer_load_ushort v15, v6, s[8:11], s34 offen
    s_waitcnt vmcnt(6)
    v_lshl_or_b32 v16, v9, 16, v8
    s_waitcnt vmcnt(4)
    v_lshl_or_b32 v17, v11, 16, v10
    s_waitcnt vmcnt(2)
    v_lshl_or_b32 v18, v13, 16, v12
    s_waitcnt vmcnt(0)
    v_lshl_or_b32 v19, v15, 16, v14
    buffer_store_dwordx4 v[16:19], v5, s[12:15], s25 offen
    s_branch L_exit_k0_kernel
L_k0_m4:
    s_load_dwordx2 s[4:5], s[0:1], 40
    s_sub_u32 s20, s2, 384
    s_lshl_b32 s20, s20, 2
    s_add_u32 s20, s20, s3
    s_and_b32 s21, s20, 15
    s_lshr_b32 s22, s20, 4
    v_lshlrev_b32 v6, 2, v4
    s_lshl_b32 s23, s21, 4
    v_add_u32 v6, s23, v6
    s_movk_i32 s24, 512
    v_mul_lo_u32 v6, v6, s24
    s_lshl_b32 s23, s22, 5
    v_add3_u32 v6, v6, s23, v3
    v_lshlrev_b32 v6, 1, v6
    s_and_b32 s25, s22, 7
    s_lshr_b32 s26, s22, 3
    s_lshl_b32 s26, s26, 4
    s_mul_i32 s25, s25, 49152
    s_add_u32 s26, s26, s21
    s_add_u32 s26, s26, 16
    s_lshl_b32 s26, s26, 10
    s_add_u32 s25, s25, s26
    s_add_u32 s25, s25, 1441792
    s_waitcnt lgkmcnt(0)
    s_mov_b32 s8, s4
    s_and_b32 s9, s5, 0xffff
    s_mov_b32 s10, 262144
    s_mov_b32 s11, 0x00020000
    s_mov_b32 s12, s6
    s_and_b32 s13, s7, 0xffff
    s_mov_b32 s14, 268435456
    s_mov_b32 s15, 0x00020000
    s_mov_b32 s27, 0
    s_mov_b32 s28, 1024
    s_mov_b32 s29, 2048
    s_mov_b32 s30, 3072
    s_mov_b32 s31, 8192
    s_mov_b32 s32, 9216
    s_mov_b32 s33, 10240
    s_mov_b32 s34, 11264
    buffer_load_ushort v8, v6, s[8:11], s27 offen
    buffer_load_ushort v9, v6, s[8:11], s28 offen
    buffer_load_ushort v10, v6, s[8:11], s29 offen
    buffer_load_ushort v11, v6, s[8:11], s30 offen
    buffer_load_ushort v12, v6, s[8:11], s31 offen
    buffer_load_ushort v13, v6, s[8:11], s32 offen
    buffer_load_ushort v14, v6, s[8:11], s33 offen
    buffer_load_ushort v15, v6, s[8:11], s34 offen
    s_waitcnt vmcnt(6)
    v_lshl_or_b32 v16, v9, 16, v8
    s_waitcnt vmcnt(4)
    v_lshl_or_b32 v17, v11, 16, v10
    s_waitcnt vmcnt(2)
    v_lshl_or_b32 v18, v13, 16, v12
    s_waitcnt vmcnt(0)
    v_lshl_or_b32 v19, v15, 16, v14
    buffer_store_dwordx4 v[16:19], v5, s[12:15], s25 offen
    s_branch L_exit_k0_kernel
L_k0_m5:
    s_load_dwordx2 s[4:5], s[0:1], 56
    s_sub_u32 s20, s2, 448
    s_lshl_b32 s20, s20, 2
    s_add_u32 s20, s20, s3
    s_and_b32 s21, s20, 15
    s_lshr_b32 s22, s20, 4
    v_lshlrev_b32 v6, 2, v4
    s_lshl_b32 s23, s21, 4
    v_add_u32 v6, s23, v6
    s_movk_i32 s24, 256
    v_mul_lo_u32 v6, v6, s24
    s_lshl_b32 s23, s22, 5
    v_add3_u32 v6, v6, s23, v3
    v_lshlrev_b32 v6, 1, v6
    s_mov_b32 s25, s22
    s_mov_b32 s26, 0
    s_mul_i32 s25, s25, 147456
    s_add_u32 s26, s26, s21
    s_add_u32 s26, s26, 0
    s_lshl_b32 s26, s26, 10
    s_add_u32 s25, s25, s26
    s_add_u32 s25, s25, 1835008
    s_waitcnt lgkmcnt(0)
    s_mov_b32 s8, s4
    s_and_b32 s9, s5, 0xffff
    s_mov_b32 s10, 131072
    s_mov_b32 s11, 0x00020000
    s_mov_b32 s12, s6
    s_and_b32 s13, s7, 0xffff
    s_mov_b32 s14, 268435456
    s_mov_b32 s15, 0x00020000
    s_mov_b32 s27, 0
    s_mov_b32 s28, 512
    s_mov_b32 s29, 1024
    s_mov_b32 s30, 1536
    s_mov_b32 s31, 4096
    s_mov_b32 s32, 4608
    s_mov_b32 s33, 5120
    s_mov_b32 s34, 5632
    buffer_load_ushort v8, v6, s[8:11], s27 offen
    buffer_load_ushort v9, v6, s[8:11], s28 offen
    buffer_load_ushort v10, v6, s[8:11], s29 offen
    buffer_load_ushort v11, v6, s[8:11], s30 offen
    buffer_load_ushort v12, v6, s[8:11], s31 offen
    buffer_load_ushort v13, v6, s[8:11], s32 offen
    buffer_load_ushort v14, v6, s[8:11], s33 offen
    buffer_load_ushort v15, v6, s[8:11], s34 offen
    s_waitcnt vmcnt(6)
    v_lshl_or_b32 v16, v9, 16, v8
    s_waitcnt vmcnt(4)
    v_lshl_or_b32 v17, v11, 16, v10
    s_waitcnt vmcnt(2)
    v_lshl_or_b32 v18, v13, 16, v12
    s_waitcnt vmcnt(0)
    v_lshl_or_b32 v19, v15, 16, v14
    buffer_store_dwordx4 v[16:19], v5, s[12:15], s25 offen
    s_branch L_exit_k0_kernel
L_k0_m6:
    s_load_dwordx2 s[4:5], s[0:1], 64
    s_sub_u32 s20, s2, 480
    s_lshl_b32 s20, s20, 2
    s_add_u32 s20, s20, s3
    s_and_b32 s21, s20, 15
    s_lshr_b32 s22, s20, 4
    v_lshlrev_b32 v6, 2, v4
    s_lshl_b32 s23, s21, 4
    v_add_u32 v6, s23, v6
    s_movk_i32 s24, 1024
    v_mul_lo_u32 v6, v6, s24
    s_lshl_b32 s23, s22, 5
    v_add3_u32 v6, v6, s23, v3
    v_lshlrev_b32 v6, 1, v6
    s_lshr_b32 s25, s22, 2
    s_and_b32 s26, s22, 3
    s_lshl_b32 s26, s26, 4
    s_mul_i32 s25, s25, 147456
    s_add_u32 s26, s26, s21
    s_add_u32 s26, s26, 16
    s_lshl_b32 s26, s26, 10
    s_add_u32 s25, s25, s26
    s_add_u32 s25, s25, 1835008
    s_waitcnt lgkmcnt(0)
    s_mov_b32 s8, s4
    s_and_b32 s9, s5, 0xffff
    s_mov_b32 s10, 524288
    s_mov_b32 s11, 0x00020000
    s_mov_b32 s12, s6
    s_and_b32 s13, s7, 0xffff
    s_mov_b32 s14, 268435456
    s_mov_b32 s15, 0x00020000
    s_mov_b32 s27, 0
    s_mov_b32 s28, 2048
    s_mov_b32 s29, 4096
    s_mov_b32 s30, 6144
    s_mov_b32 s31, 16384
    s_mov_b32 s32, 18432
    s_mov_b32 s33, 20480
    s_mov_b32 s34, 22528
    buffer_load_ushort v8, v6, s[8:11], s27 offen
    buffer_load_ushort v9, v6, s[8:11], s28 offen
    buffer_load_ushort v10, v6, s[8:11], s29 offen
    buffer_load_ushort v11, v6, s[8:11], s30 offen
    buffer_load_ushort v12, v6, s[8:11], s31 offen
    buffer_load_ushort v13, v6, s[8:11], s32 offen
    buffer_load_ushort v14, v6, s[8:11], s33 offen
    buffer_load_ushort v15, v6, s[8:11], s34 offen
    s_waitcnt vmcnt(6)
    v_lshl_or_b32 v16, v9, 16, v8
    s_waitcnt vmcnt(4)
    v_lshl_or_b32 v17, v11, 16, v10
    s_waitcnt vmcnt(2)
    v_lshl_or_b32 v18, v13, 16, v12
    s_waitcnt vmcnt(0)
    v_lshl_or_b32 v19, v15, 16, v14
    buffer_store_dwordx4 v[16:19], v5, s[12:15], s25 offen
    s_branch L_exit_k0_kernel
L_k0_m7:
    s_load_dwordx2 s[4:5], s[0:1], 72
    s_sub_u32 s20, s2, 608
    s_lshl_b32 s20, s20, 2
    s_add_u32 s20, s20, s3
    s_and_b32 s21, s20, 63
    s_lshr_b32 s22, s20, 6
    v_lshlrev_b32 v6, 2, v4
    s_lshl_b32 s23, s21, 4
    v_add_u32 v6, s23, v6
    s_movk_i32 s24, 256
    v_mul_lo_u32 v6, v6, s24
    s_lshl_b32 s23, s22, 5
    v_add3_u32 v6, v6, s23, v3
    v_lshlrev_b32 v6, 1, v6
    s_mov_b32 s25, s22
    s_mov_b32 s26, 0
    s_mul_i32 s25, s25, 147456
    s_add_u32 s26, s26, s21
    s_add_u32 s26, s26, 80
    s_lshl_b32 s26, s26, 10
    s_add_u32 s25, s25, s26
    s_add_u32 s25, s25, 1835008
    s_waitcnt lgkmcnt(0)
    s_mov_b32 s8, s4
    s_and_b32 s9, s5, 0xffff
    s_mov_b32 s10, 524288
    s_mov_b32 s11, 0x00020000
    s_mov_b32 s12, s6
    s_and_b32 s13, s7, 0xffff
    s_mov_b32 s14, 268435456
    s_mov_b32 s15, 0x00020000
    s_mov_b32 s27, 0
    s_mov_b32 s28, 512
    s_mov_b32 s29, 1024
    s_mov_b32 s30, 1536
    s_mov_b32 s31, 4096
    s_mov_b32 s32, 4608
    s_mov_b32 s33, 5120
    s_mov_b32 s34, 5632
    buffer_load_ushort v8, v6, s[8:11], s27 offen
    buffer_load_ushort v9, v6, s[8:11], s28 offen
    buffer_load_ushort v10, v6, s[8:11], s29 offen
    buffer_load_ushort v11, v6, s[8:11], s30 offen
    buffer_load_ushort v12, v6, s[8:11], s31 offen
    buffer_load_ushort v13, v6, s[8:11], s32 offen
    buffer_load_ushort v14, v6, s[8:11], s33 offen
    buffer_load_ushort v15, v6, s[8:11], s34 offen
    s_waitcnt vmcnt(6)
    v_lshl_or_b32 v16, v9, 16, v8
    s_waitcnt vmcnt(4)
    v_lshl_or_b32 v17, v11, 16, v10
    s_waitcnt vmcnt(2)
    v_lshl_or_b32 v18, v13, 16, v12
    s_waitcnt vmcnt(0)
    v_lshl_or_b32 v19, v15, 16, v14
    buffer_store_dwordx4 v[16:19], v5, s[12:15], s25 offen
    s_branch L_exit_k0_kernel
L_exit_k0_kernel:
    s_endpgm
.globl k1_kernel
.p2align 8
.type k1_kernel,@function
k1_kernel:
    s_cmp_ge_u32 s2, 250
    s_cbranch_scc1 L_exit_k1_kernel
    s_load_dwordx2 s[4:5], s[0:1], 0
    s_load_dwordx2 s[6:7], s[0:1], 96
    s_load_dwordx2 s[34:35], s[0:1], 80
    s_load_dwordx2 s[36:37], s[0:1], 48
    v_and_b32 v8, 63, v0
    v_lshrrev_b32 v9, 6, v0
    v_lshlrev_b32 v1, 4, v8
    v_readfirstlane_b32 s3, v9
    v_and_b32 v10, 31, v8
    v_lshrrev_b32 v11, 5, v8
    v_add_u32 v2, 65536, v1
    v_lshlrev_b32 v12, 11, v9
    v_add_u32 v3, v2, v12
    v_lshlrev_b32 v12, 13, v9
    v_add_u32 v4, v1, v12
    v_mul_u32_u24 v6, 144, v10
    v_add_u32 v6, 81920, v6
    v_lshlrev_b32 v12, 4, v9
    v_lshlrev_b32 v13, 3, v11
    v_add3_u32 v5, v6, v12, v13
    v_lshlrev_b32 v7, 9, v10
    v_add_u32 v7, v7, v13
    s_mov_b32 s29, s2
    s_cmp_ge_u32 s2, 125
    s_cselect_b32 s30, 1, 0
    s_mul_i32 s25, s30, 125
    s_sub_u32 s31, s2, s25
    s_waitcnt lgkmcnt(0)
    s_mov_b32 s8, s4
    s_and_b32 s9, s5, 0xffff
    s_mov_b32 s10, 4096000
    s_mov_b32 s11, 0x00020000
    s_mov_b32 s12, s6
    s_and_b32 s13, s7, 0xffff
    s_mov_b32 s14, 268435456
    s_mov_b32 s15, 0x00020000
    s_mov_b32 s16, s34
    s_and_b32 s17, s35, 0xffff
    s_mov_b32 s18, 4096000
    s_mov_b32 s19, 0x00020000
    s_mov_b32 s20, s36
    s_and_b32 s21, s37, 0xffff
    s_mov_b32 s22, 2560
    s_mov_b32 s23, 0x00020000
    s_mul_i32 s24, s3, 180224
    s_add_u32 s24, s24, 0
    s_lshl_b32 s25, s29, 14
    s_lshl_b32 s26, s3, 6
    s_add_u32 s25, s25, s26
    buffer_load_dwordx2 v[240:241], v7, s[8:11], s25 offen offset:0
    buffer_load_dwordx2 v[242:243], v7, s[8:11], s25 offen offset:16
    buffer_load_dwordx2 v[244:245], v7, s[8:11], s25 offen offset:32
    buffer_load_dwordx2 v[246:247], v7, s[8:11], s25 offen offset:48
    buffer_load_dwordx4 v[128:131], v1, s[12:15], s24 offen offset:0
    buffer_load_dwordx4 v[132:135], v1, s[12:15], s24 offen offset:1024
    buffer_load_dwordx4 v[136:139], v1, s[12:15], s24 offen offset:2048
    buffer_load_dwordx4 v[140:143], v1, s[12:15], s24 offen offset:3072
    s_add_u32 s24, s24, 4096
    buffer_load_dwordx4 v[144:147], v1, s[12:15], s24 offen offset:0
    buffer_load_dwordx4 v[148:151], v1, s[12:15], s24 offen offset:1024
    buffer_load_dwordx4 v[152:155], v1, s[12:15], s24 offen offset:2048
    buffer_load_dwordx4 v[156:159], v1, s[12:15], s24 offen offset:3072
    s_add_u32 s24, s24, 4096
    buffer_load_dwordx4 v[160:163], v1, s[12:15], s24 offen offset:0
    buffer_load_dwordx4 v[164:167], v1, s[12:15], s24 offen offset:1024
    buffer_load_dwordx4 v[168:171], v1, s[12:15], s24 offen offset:2048
    buffer_load_dwordx4 v[172:175], v1, s[12:15], s24 offen offset:3072
    s_add_u32 s24, s24, 4096
    buffer_load_dwordx4 v[176:179], v1, s[12:15], s24 offen offset:0
    buffer_load_dwordx4 v[180:183], v1, s[12:15], s24 offen offset:1024
    buffer_load_dwordx4 v[184:187], v1, s[12:15], s24 offen offset:2048
    buffer_load_dwordx4 v[188:191], v1, s[12:15], s24 offen offset:3072
    s_add_u32 s24, s24, 4096
    s_waitcnt vmcnt(19)
    v_lshlrev_b32 v224, 16, v240
    v_and_b32 v225, 0xffff0000, v240
    v_lshlrev_b32 v226, 16, v241
    v_and_b32 v227, 0xffff0000, v241
    s_waitcnt vmcnt(18)
    v_lshlrev_b32 v228, 16, v242
    v_and_b32 v229, 0xffff0000, v242
    v_lshlrev_b32 v230, 16, v243
    v_and_b32 v231, 0xffff0000, v243
    s_waitcnt vmcnt(17)
    v_lshlrev_b32 v232, 16, v244
    v_and_b32 v233, 0xffff0000, v244
    v_lshlrev_b32 v234, 16, v245
    v_and_b32 v235, 0xffff0000, v245
    s_waitcnt vmcnt(16)
    v_lshlrev_b32 v236, 16, v246
    v_and_b32 v237, 0xffff0000, v246
    v_lshlrev_b32 v238, 16, v247
    v_and_b32 v239, 0xffff0000, v247
    v_add_f32 v8, v224, v225
    v_add_f32 v9, v226, v227
    v_add_f32 v8, v8, v228
    v_add_f32 v9, v9, v229
    v_add_f32 v8, v8, v230
    v_add_f32 v9, v9, v231
    v_add_f32 v8, v8, v232
    v_add_f32 v9, v9, v233
    v_add_f32 v8, v8, v234
    v_add_f32 v9, v9, v235
    v_add_f32 v8, v8, v236
    v_add_f32 v9, v9, v237
    v_add_f32 v8, v8, v238
    v_add_f32 v9, v9, v239
    v_add_f32 v8, v8, v9
    v_mul_f32 v8, 0x3d800000, v8
    v_sub_f32 v10, v224, v8
    v_mul_f32 v14, v10, v10
    v_sub_f32 v11, v225, v8
    v_mul_f32 v15, v11, v11
    v_sub_f32 v12, v226, v8
    v_fma_f32 v14, v12, v12, v14
    v_sub_f32 v13, v227, v8
    v_fma_f32 v15, v13, v13, v15
    v_sub_f32 v10, v228, v8
    v_fma_f32 v14, v10, v10, v14
    v_sub_f32 v11, v229, v8
    v_fma_f32 v15, v11, v11, v15
    v_sub_f32 v12, v230, v8
    v_fma_f32 v14, v12, v12, v14
    v_sub_f32 v13, v231, v8
    v_fma_f32 v15, v13, v13, v15
    v_sub_f32 v10, v232, v8
    v_fma_f32 v14, v10, v10, v14
    v_sub_f32 v11, v233, v8
    v_fma_f32 v15, v11, v11, v15
    v_sub_f32 v12, v234, v8
    v_fma_f32 v14, v12, v12, v14
    v_sub_f32 v13, v235, v8
    v_fma_f32 v15, v13, v13, v15
    v_sub_f32 v10, v236, v8
    v_fma_f32 v14, v10, v10, v14
    v_sub_f32 v11, v237, v8
    v_fma_f32 v15, v11, v11, v15
    v_sub_f32 v12, v238, v8
    v_fma_f32 v14, v12, v12, v14
    v_sub_f32 v13, v239, v8
    v_fma_f32 v15, v13, v13, v15
    v_add_f32 v9, v14, v15
    ds_write_b64 v5, v[8:9] offset:0
    s_waitcnt lgkmcnt(0)
    s_barrier
    ds_read_b128 v[64:67], v6 offset:0
    ds_read_b128 v[68:71], v6 offset:16
    ds_read_b128 v[72:75], v6 offset:32
    ds_read_b128 v[76:79], v6 offset:48
    ds_read_b128 v[80:83], v6 offset:64
    ds_read_b128 v[84:87], v6 offset:80
    ds_read_b128 v[88:91], v6 offset:96
    ds_read_b128 v[92:95], v6 offset:112
    s_waitcnt lgkmcnt(7)
    v_add_f32 v8, v64, v66
    s_waitcnt lgkmcnt(6)
    v_add_f32 v9, v68, v70
    s_waitcnt lgkmcnt(5)
    v_add_f32 v8, v8, v72
    v_add_f32 v9, v9, v74
    s_waitcnt lgkmcnt(4)
    v_add_f32 v8, v8, v76
    v_add_f32 v9, v9, v78
    s_waitcnt lgkmcnt(3)
    v_add_f32 v8, v8, v80
    v_add_f32 v9, v9, v82
    s_waitcnt lgkmcnt(2)
    v_add_f32 v8, v8, v84
    v_add_f32 v9, v9, v86
    s_waitcnt lgkmcnt(1)
    v_add_f32 v8, v8, v88
    v_add_f32 v9, v9, v90
    s_waitcnt lgkmcnt(0)
    v_add_f32 v8, v8, v92
    v_add_f32 v9, v9, v94
    v_add_f32 v8, v8, v9
    v_mul_f32 v8, 0x3d800000, v8
    v_add_f32 v9, v65, v67
    v_add_f32 v10, v69, v71
    v_add_f32 v9, v9, v73
    v_add_f32 v10, v10, v75
    v_add_f32 v9, v9, v77
    v_add_f32 v10, v10, v79
    v_add_f32 v9, v9, v81
    v_add_f32 v10, v10, v83
    v_add_f32 v9, v9, v85
    v_add_f32 v10, v10, v87
    v_add_f32 v9, v9, v89
    v_add_f32 v10, v10, v91
    v_add_f32 v9, v9, v93
    v_add_f32 v10, v10, v95
    v_add_f32 v9, v9, v10
    v_sub_f32 v12, v64, v8
    v_mul_f32 v10, v12, v12
    v_sub_f32 v13, v66, v8
    v_mul_f32 v11, v13, v13
    v_sub_f32 v14, v68, v8
    v_fma_f32 v10, v14, v14, v10
    v_sub_f32 v15, v70, v8
    v_fma_f32 v11, v15, v15, v11
    v_sub_f32 v12, v72, v8
    v_fma_f32 v10, v12, v12, v10
    v_sub_f32 v13, v74, v8
    v_fma_f32 v11, v13, v13, v11
    v_sub_f32 v14, v76, v8
    v_fma_f32 v10, v14, v14, v10
    v_sub_f32 v15, v78, v8
    v_fma_f32 v11, v15, v15, v11
    v_sub_f32 v12, v80, v8
    v_fma_f32 v10, v12, v12, v10
    v_sub_f32 v13, v82, v8
    v_fma_f32 v11, v13, v13, v11
    v_sub_f32 v14, v84, v8
    v_fma_f32 v10, v14, v14, v10
    v_sub_f32 v15, v86, v8
    v_fma_f32 v11, v15, v15, v11
    v_sub_f32 v12, v88, v8
    v_fma_f32 v10, v12, v12, v10
    v_sub_f32 v13, v90, v8
    v_fma_f32 v11, v13, v13, v11
    v_sub_f32 v14, v92, v8
    v_fma_f32 v10, v14, v14, v10
    v_sub_f32 v15, v94, v8
    v_fma_f32 v11, v15, v15, v11
    v_add_f32 v10, v10, v11
    v_mov_b32 v11, 0x41800000
    v_fma_f32 v9, v10, v11, v9
    v_mul_f32 v9, 0x3b800000, v9
    v_cvt_pk_bf16_f32 v10, v8, v9
    v_lshlrev_b32 v8, 16, v10
    v_and_b32 v9, 0xffff0000, v10
    v_add_f32 v9, 0x3727c5ac, v9
    v_cvt_pk_bf16_f32 v9, v9, v9
    v_lshlrev_b32 v9, 16, v9
    v_sqrt_f32 v9, v9
    s_nop 0
    v_cvt_pk_bf16_f32 v9, v9, v9
    v_lshlrev_b32 v9, 16, v9
    v_rcp_f32 v9, v9
    v_sub_f32 v10, v224, v8
    v_sub_f32 v11, v225, v8
    v_sub_f32 v12, v226, v8
    v_sub_f32 v13, v227, v8
    v_sub_f32 v14, v228, v8
    v_sub_f32 v15, v229, v8
    v_sub_f32 v16, v230, v8
    v_sub_f32 v17, v231, v8
    v_sub_f32 v18, v232, v8
    v_sub_f32 v19, v233, v8
    v_sub_f32 v20, v234, v8
    v_sub_f32 v21, v235, v8
    v_sub_f32 v22, v236, v8
    v_sub_f32 v23, v237, v8
    v_sub_f32 v24, v238, v8
    v_sub_f32 v25, v239, v8
    v_mul_f32 v10, v10, v9
    v_mul_f32 v11, v11, v9
    v_mul_f32 v12, v12, v9
    v_mul_f32 v13, v13, v9
    v_mul_f32 v14, v14, v9
    v_mul_f32 v15, v15, v9
    v_mul_f32 v16, v16, v9
    v_mul_f32 v17, v17, v9
    v_mul_f32 v18, v18, v9
    v_mul_f32 v19, v19, v9
    v_mul_f32 v20, v20, v9
    v_mul_f32 v21, v21, v9
    v_mul_f32 v22, v22, v9
    v_mul_f32 v23, v23, v9
    v_mul_f32 v24, v24, v9
    v_mul_f32 v25, v25, v9
    v_cvt_pk_bf16_f32 v240, v10, v11
    v_cvt_pk_bf16_f32 v241, v12, v13
    v_cvt_pk_bf16_f32 v242, v14, v15
    v_cvt_pk_bf16_f32 v243, v16, v17
    v_cvt_pk_bf16_f32 v244, v18, v19
    v_cvt_pk_bf16_f32 v245, v20, v21
    v_cvt_pk_bf16_f32 v246, v22, v23
    v_cvt_pk_bf16_f32 v247, v24, v25
    ds_write_b128 v3, v[240:243]
    ds_write_b128 v3, v[244:247] offset:1024
    s_waitcnt lgkmcnt(0)
    s_barrier
    ds_read_b128 v[64:67], v2 offset:0
    ds_read_b128 v[68:71], v2 offset:1024
    ds_read_b128 v[72:75], v2 offset:2048
    ds_read_b128 v[76:79], v2 offset:3072
    ds_read_b128 v[80:83], v2 offset:4096
    ds_read_b128 v[84:87], v2 offset:5120
    ds_read_b128 v[88:91], v2 offset:6144
    ds_read_b128 v[92:95], v2 offset:7168
    ds_read_b128 v[96:99], v2 offset:8192
    ds_read_b128 v[100:103], v2 offset:9216
    ds_read_b128 v[104:107], v2 offset:10240
    ds_read_b128 v[108:111], v2 offset:11264
    ds_read_b128 v[112:115], v2 offset:12288
    ds_read_b128 v[116:119], v2 offset:13312
    ds_read_b128 v[120:123], v2 offset:14336
    ds_read_b128 v[124:127], v2 offset:15360
    s_waitcnt vmcnt(15) lgkmcnt(15)
    v_mfma_f32_32x32x16_bf16 v[192:207], v[128:131], v[64:67], 0
    buffer_load_dwordx4 v[128:131], v1, s[12:15], s24 offen offset:0
    s_waitcnt vmcnt(15) lgkmcnt(14)
    v_mfma_f32_32x32x16_bf16 v[192:207], v[132:135], v[68:71], v[192:207]
    buffer_load_dwordx4 v[132:135], v1, s[12:15], s24 offen offset:1024
    s_waitcnt vmcnt(15) lgkmcnt(13)
    v_mfma_f32_32x32x16_bf16 v[192:207], v[136:139], v[72:75], v[192:207]
    buffer_load_dwordx4 v[136:139], v1, s[12:15], s24 offen offset:2048
    s_waitcnt vmcnt(15) lgkmcnt(12)
    v_mfma_f32_32x32x16_bf16 v[192:207], v[140:143], v[76:79], v[192:207]
    buffer_load_dwordx4 v[140:143], v1, s[12:15], s24 offen offset:3072
    s_add_u32 s24, s24, 4096
    s_waitcnt vmcnt(15) lgkmcnt(11)
    v_mfma_f32_32x32x16_bf16 v[192:207], v[144:147], v[80:83], v[192:207]
    buffer_load_dwordx4 v[144:147], v1, s[12:15], s24 offen offset:0
    s_waitcnt vmcnt(15) lgkmcnt(10)
    v_mfma_f32_32x32x16_bf16 v[192:207], v[148:151], v[84:87], v[192:207]
    buffer_load_dwordx4 v[148:151], v1, s[12:15], s24 offen offset:1024
    s_waitcnt vmcnt(15) lgkmcnt(9)
    v_mfma_f32_32x32x16_bf16 v[192:207], v[152:155], v[88:91], v[192:207]
    buffer_load_dwordx4 v[152:155], v1, s[12:15], s24 offen offset:2048
    s_waitcnt vmcnt(15) lgkmcnt(8)
    v_mfma_f32_32x32x16_bf16 v[192:207], v[156:159], v[92:95], v[192:207]
    buffer_load_dwordx4 v[156:159], v1, s[12:15], s24 offen offset:3072
    s_add_u32 s24, s24, 4096
    s_waitcnt vmcnt(15) lgkmcnt(7)
    v_mfma_f32_32x32x16_bf16 v[192:207], v[160:163], v[96:99], v[192:207]
    buffer_load_dwordx4 v[160:163], v1, s[12:15], s24 offen offset:0
    s_waitcnt vmcnt(15) lgkmcnt(6)
    v_mfma_f32_32x32x16_bf16 v[192:207], v[164:167], v[100:103], v[192:207]
    buffer_load_dwordx4 v[164:167], v1, s[12:15], s24 offen offset:1024
    s_waitcnt vmcnt(15) lgkmcnt(5)
    v_mfma_f32_32x32x16_bf16 v[192:207], v[168:171], v[104:107], v[192:207]
    buffer_load_dwordx4 v[168:171], v1, s[12:15], s24 offen offset:2048
    s_waitcnt vmcnt(15) lgkmcnt(4)
    v_mfma_f32_32x32x16_bf16 v[192:207], v[172:175], v[108:111], v[192:207]
    buffer_load_dwordx4 v[172:175], v1, s[12:15], s24 offen offset:3072
    s_add_u32 s24, s24, 4096
    s_waitcnt vmcnt(15) lgkmcnt(3)
    v_mfma_f32_32x32x16_bf16 v[192:207], v[176:179], v[112:115], v[192:207]
    buffer_load_dwordx4 v[176:179], v1, s[12:15], s24 offen offset:0
    s_waitcnt vmcnt(15) lgkmcnt(2)
    v_mfma_f32_32x32x16_bf16 v[192:207], v[180:183], v[116:119], v[192:207]
    buffer_load_dwordx4 v[180:183], v1, s[12:15], s24 offen offset:1024
    s_waitcnt vmcnt(15) lgkmcnt(1)
    v_mfma_f32_32x32x16_bf16 v[192:207], v[184:187], v[120:123], v[192:207]
    buffer_load_dwordx4 v[184:187], v1, s[12:15], s24 offen offset:2048
    s_waitcnt vmcnt(15) lgkmcnt(0)
    v_mfma_f32_32x32x16_bf16 v[192:207], v[188:191], v[124:127], v[192:207]
    buffer_load_dwordx4 v[188:191], v1, s[12:15], s24 offen offset:3072
    s_add_u32 s24, s24, 4096
    s_nop 9
    v_cvt_pk_bf16_f32 v40, v192, v193
    v_cvt_pk_bf16_f32 v41, v194, v195
    v_cvt_pk_bf16_f32 v42, v196, v197
    v_cvt_pk_bf16_f32 v43, v198, v199
    v_cvt_pk_bf16_f32 v44, v200, v201
    v_cvt_pk_bf16_f32 v45, v202, v203
    v_cvt_pk_bf16_f32 v46, v204, v205
    v_cvt_pk_bf16_f32 v47, v206, v207
    v_lshlrev_b32 v8, 16, v40
    v_and_b32 v9, 0xffff0000, v40
    v_lshlrev_b32 v10, 16, v41
    v_and_b32 v11, 0xffff0000, v41
    v_lshlrev_b32 v12, 16, v42
    v_and_b32 v13, 0xffff0000, v42
    v_lshlrev_b32 v14, 16, v43
    v_and_b32 v15, 0xffff0000, v43
    v_lshlrev_b32 v16, 16, v44
    v_and_b32 v17, 0xffff0000, v44
    v_lshlrev_b32 v18, 16, v45
    v_and_b32 v19, 0xffff0000, v45
    v_lshlrev_b32 v20, 16, v46
    v_and_b32 v21, 0xffff0000, v46
    v_lshlrev_b32 v22, 16, v47
    v_and_b32 v23, 0xffff0000, v47
    v_mul_f32 v24, 0xbfb8aa3b, v8
    v_mul_f32 v25, 0xbfb8aa3b, v9
    v_mul_f32 v26, 0xbfb8aa3b, v10
    v_mul_f32 v27, 0xbfb8aa3b, v11
    v_mul_f32 v28, 0xbfb8aa3b, v12
    v_mul_f32 v29, 0xbfb8aa3b, v13
    v_mul_f32 v30, 0xbfb8aa3b, v14
    v_mul_f32 v31, 0xbfb8aa3b, v15
    v_mul_f32 v32, 0xbfb8aa3b, v16
    v_mul_f32 v33, 0xbfb8aa3b, v17
    v_mul_f32 v34, 0xbfb8aa3b, v18
    v_mul_f32 v35, 0xbfb8aa3b, v19
    v_mul_f32 v36, 0xbfb8aa3b, v20
    v_mul_f32 v37, 0xbfb8aa3b, v21
    v_mul_f32 v38, 0xbfb8aa3b, v22
    v_mul_f32 v39, 0xbfb8aa3b, v23
    v_exp_f32 v24, v24
    v_exp_f32 v25, v25
    v_exp_f32 v26, v26
    v_exp_f32 v27, v27
    v_exp_f32 v28, v28
    v_exp_f32 v29, v29
    v_exp_f32 v30, v30
    v_exp_f32 v31, v31
    v_exp_f32 v32, v32
    v_exp_f32 v33, v33
    v_exp_f32 v34, v34
    v_exp_f32 v35, v35
    v_exp_f32 v36, v36
    v_exp_f32 v37, v37
    v_exp_f32 v38, v38
    v_exp_f32 v39, v39
    v_add_f32 v24, 1.0, v24
    v_add_f32 v25, 1.0, v25
    v_add_f32 v26, 1.0, v26
    v_add_f32 v27, 1.0, v27
    v_add_f32 v28, 1.0, v28
    v_add_f32 v29, 1.0, v29
    v_add_f32 v30, 1.0, v30
    v_add_f32 v31, 1.0, v31
    v_add_f32 v32, 1.0, v32
    v_add_f32 v33, 1.0, v33
    v_add_f32 v34, 1.0, v34
    v_add_f32 v35, 1.0, v35
    v_add_f32 v36, 1.0, v36
    v_add_f32 v37, 1.0, v37
    v_add_f32 v38, 1.0, v38
    v_add_f32 v39, 1.0, v39
    v_rcp_f32 v24, v24
    v_rcp_f32 v25, v25
    v_rcp_f32 v26, v26
    v_rcp_f32 v27, v27
    v_rcp_f32 v28, v28
    v_rcp_f32 v29, v29
    v_rcp_f32 v30, v30
    v_rcp_f32 v31, v31
    v_rcp_f32 v32, v32
    v_rcp_f32 v33, v33
    v_rcp_f32 v34, v34
    v_rcp_f32 v35, v35
    v_rcp_f32 v36, v36
    v_rcp_f32 v37, v37
    v_rcp_f32 v38, v38
    v_rcp_f32 v39, v39
    v_mul_f32 v8, v8, v24
    v_mul_f32 v9, v9, v25
    v_mul_f32 v10, v10, v26
    v_mul_f32 v11, v11, v27
    v_mul_f32 v12, v12, v28
    v_mul_f32 v13, v13, v29
    v_mul_f32 v14, v14, v30
    v_mul_f32 v15, v15, v31
    v_mul_f32 v16, v16, v32
    v_mul_f32 v17, v17, v33
    v_mul_f32 v18, v18, v34
    v_mul_f32 v19, v19, v35
    v_mul_f32 v20, v20, v36
    v_mul_f32 v21, v21, v37
    v_mul_f32 v22, v22, v38
    v_mul_f32 v23, v23, v39
    v_cvt_pk_bf16_f32 v240, v8, v9
    v_cvt_pk_bf16_f32 v241, v10, v11
    v_cvt_pk_bf16_f32 v242, v12, v13
    v_cvt_pk_bf16_f32 v243, v14, v15
    v_cvt_pk_bf16_f32 v244, v16, v17
    v_cvt_pk_bf16_f32 v245, v18, v19
    v_cvt_pk_bf16_f32 v246, v20, v21
    v_cvt_pk_bf16_f32 v247, v22, v23
    ds_write_b128 v4, v[240:243] offset:0
    ds_write_b128 v4, v[244:247] offset:1024
    s_waitcnt vmcnt(15)
    v_mfma_f32_32x32x16_bf16 v[208:223], v[128:131], v[64:67], 0
    buffer_load_dwordx4 v[128:131], v1, s[12:15], s24 offen offset:0
    s_waitcnt vmcnt(15)
    v_mfma_f32_32x32x16_bf16 v[208:223], v[132:135], v[68:71], v[208:223]
    buffer_load_dwordx4 v[132:135], v1, s[12:15], s24 offen offset:1024
    s_waitcnt vmcnt(15)
    v_mfma_f32_32x32x16_bf16 v[208:223], v[136:139], v[72:75], v[208:223]
    buffer_load_dwordx4 v[136:139], v1, s[12:15], s24 offen offset:2048
    s_waitcnt vmcnt(15)
    v_mfma_f32_32x32x16_bf16 v[208:223], v[140:143], v[76:79], v[208:223]
    buffer_load_dwordx4 v[140:143], v1, s[12:15], s24 offen offset:3072
    s_add_u32 s24, s24, 4096
    s_waitcnt vmcnt(15)
    v_mfma_f32_32x32x16_bf16 v[208:223], v[144:147], v[80:83], v[208:223]
    buffer_load_dwordx4 v[144:147], v1, s[12:15], s24 offen offset:0
    s_waitcnt vmcnt(15)
    v_mfma_f32_32x32x16_bf16 v[208:223], v[148:151], v[84:87], v[208:223]
    buffer_load_dwordx4 v[148:151], v1, s[12:15], s24 offen offset:1024
    s_waitcnt vmcnt(15)
    v_mfma_f32_32x32x16_bf16 v[208:223], v[152:155], v[88:91], v[208:223]
    buffer_load_dwordx4 v[152:155], v1, s[12:15], s24 offen offset:2048
    s_waitcnt vmcnt(15)
    v_mfma_f32_32x32x16_bf16 v[208:223], v[156:159], v[92:95], v[208:223]
    buffer_load_dwordx4 v[156:159], v1, s[12:15], s24 offen offset:3072
    s_add_u32 s24, s24, 4096
    s_waitcnt vmcnt(15)
    v_mfma_f32_32x32x16_bf16 v[208:223], v[160:163], v[96:99], v[208:223]
    buffer_load_dwordx4 v[160:163], v1, s[12:15], s24 offen offset:0
    s_waitcnt vmcnt(15)
    v_mfma_f32_32x32x16_bf16 v[208:223], v[164:167], v[100:103], v[208:223]
    buffer_load_dwordx4 v[164:167], v1, s[12:15], s24 offen offset:1024
    s_waitcnt vmcnt(15)
    v_mfma_f32_32x32x16_bf16 v[208:223], v[168:171], v[104:107], v[208:223]
    buffer_load_dwordx4 v[168:171], v1, s[12:15], s24 offen offset:2048
    s_waitcnt vmcnt(15)
    v_mfma_f32_32x32x16_bf16 v[208:223], v[172:175], v[108:111], v[208:223]
    buffer_load_dwordx4 v[172:175], v1, s[12:15], s24 offen offset:3072
    s_add_u32 s24, s24, 4096
    s_waitcnt vmcnt(15)
    v_mfma_f32_32x32x16_bf16 v[208:223], v[176:179], v[112:115], v[208:223]
    buffer_load_dwordx4 v[176:179], v1, s[12:15], s24 offen offset:0
    s_waitcnt vmcnt(15)
    v_mfma_f32_32x32x16_bf16 v[208:223], v[180:183], v[116:119], v[208:223]
    buffer_load_dwordx4 v[180:183], v1, s[12:15], s24 offen offset:1024
    s_waitcnt vmcnt(15)
    v_mfma_f32_32x32x16_bf16 v[208:223], v[184:187], v[120:123], v[208:223]
    buffer_load_dwordx4 v[184:187], v1, s[12:15], s24 offen offset:2048
    s_waitcnt vmcnt(15)
    v_mfma_f32_32x32x16_bf16 v[208:223], v[188:191], v[124:127], v[208:223]
    buffer_load_dwordx4 v[188:191], v1, s[12:15], s24 offen offset:3072
    s_add_u32 s24, s24, 4096
    s_nop 9
    v_cvt_pk_bf16_f32 v40, v208, v209
    v_cvt_pk_bf16_f32 v41, v210, v211
    v_cvt_pk_bf16_f32 v42, v212, v213
    v_cvt_pk_bf16_f32 v43, v214, v215
    v_cvt_pk_bf16_f32 v44, v216, v217
    v_cvt_pk_bf16_f32 v45, v218, v219
    v_cvt_pk_bf16_f32 v46, v220, v221
    v_cvt_pk_bf16_f32 v47, v222, v223
    v_lshlrev_b32 v8, 16, v40
    v_and_b32 v9, 0xffff0000, v40
    v_lshlrev_b32 v10, 16, v41
    v_and_b32 v11, 0xffff0000, v41
    v_lshlrev_b32 v12, 16, v42
    v_and_b32 v13, 0xffff0000, v42
    v_lshlrev_b32 v14, 16, v43
    v_and_b32 v15, 0xffff0000, v43
    v_lshlrev_b32 v16, 16, v44
    v_and_b32 v17, 0xffff0000, v44
    v_lshlrev_b32 v18, 16, v45
    v_and_b32 v19, 0xffff0000, v45
    v_lshlrev_b32 v20, 16, v46
    v_and_b32 v21, 0xffff0000, v46
    v_lshlrev_b32 v22, 16, v47
    v_and_b32 v23, 0xffff0000, v47
    v_mul_f32 v24, 0xbfb8aa3b, v8
    v_mul_f32 v25, 0xbfb8aa3b, v9
    v_mul_f32 v26, 0xbfb8aa3b, v10
    v_mul_f32 v27, 0xbfb8aa3b, v11
    v_mul_f32 v28, 0xbfb8aa3b, v12
    v_mul_f32 v29, 0xbfb8aa3b, v13
    v_mul_f32 v30, 0xbfb8aa3b, v14
    v_mul_f32 v31, 0xbfb8aa3b, v15
    v_mul_f32 v32, 0xbfb8aa3b, v16
    v_mul_f32 v33, 0xbfb8aa3b, v17
    v_mul_f32 v34, 0xbfb8aa3b, v18
    v_mul_f32 v35, 0xbfb8aa3b, v19
    v_mul_f32 v36, 0xbfb8aa3b, v20
    v_mul_f32 v37, 0xbfb8aa3b, v21
    v_mul_f32 v38, 0xbfb8aa3b, v22
    v_mul_f32 v39, 0xbfb8aa3b, v23
    v_exp_f32 v24, v24
    v_exp_f32 v25, v25
    v_exp_f32 v26, v26
    v_exp_f32 v27, v27
    v_exp_f32 v28, v28
    v_exp_f32 v29, v29
    v_exp_f32 v30, v30
    v_exp_f32 v31, v31
    v_exp_f32 v32, v32
    v_exp_f32 v33, v33
    v_exp_f32 v34, v34
    v_exp_f32 v35, v35
    v_exp_f32 v36, v36
    v_exp_f32 v37, v37
    v_exp_f32 v38, v38
    v_exp_f32 v39, v39
    v_add_f32 v24, 1.0, v24
    v_add_f32 v25, 1.0, v25
    v_add_f32 v26, 1.0, v26
    v_add_f32 v27, 1.0, v27
    v_add_f32 v28, 1.0, v28
    v_add_f32 v29, 1.0, v29
    v_add_f32 v30, 1.0, v30
    v_add_f32 v31, 1.0, v31
    v_add_f32 v32, 1.0, v32
    v_add_f32 v33, 1.0, v33
    v_add_f32 v34, 1.0, v34
    v_add_f32 v35, 1.0, v35
    v_add_f32 v36, 1.0, v36
    v_add_f32 v37, 1.0, v37
    v_add_f32 v38, 1.0, v38
    v_add_f32 v39, 1.0, v39
    v_rcp_f32 v24, v24
    v_rcp_f32 v25, v25
    v_rcp_f32 v26, v26
    v_rcp_f32 v27, v27
    v_rcp_f32 v28, v28
    v_rcp_f32 v29, v29
    v_rcp_f32 v30, v30
    v_rcp_f32 v31, v31
    v_rcp_f32 v32, v32
    v_rcp_f32 v33, v33
    v_rcp_f32 v34, v34
    v_rcp_f32 v35, v35
    v_rcp_f32 v36, v36
    v_rcp_f32 v37, v37
    v_rcp_f32 v38, v38
    v_rcp_f32 v39, v39
    v_mul_f32 v8, v8, v24
    v_mul_f32 v9, v9, v25
    v_mul_f32 v10, v10, v26
    v_mul_f32 v11, v11, v27
    v_mul_f32 v12, v12, v28
    v_mul_f32 v13, v13, v29
    v_mul_f32 v14, v14, v30
    v_mul_f32 v15, v15, v31
    v_mul_f32 v16, v16, v32
    v_mul_f32 v17, v17, v33
    v_mul_f32 v18, v18, v34
    v_mul_f32 v19, v19, v35
    v_mul_f32 v20, v20, v36
    v_mul_f32 v21, v21, v37
    v_mul_f32 v22, v22, v38
    v_mul_f32 v23, v23, v39
    v_cvt_pk_bf16_f32 v240, v8, v9
    v_cvt_pk_bf16_f32 v241, v10, v11
    v_cvt_pk_bf16_f32 v242, v12, v13
    v_cvt_pk_bf16_f32 v243, v14, v15
    v_cvt_pk_bf16_f32 v244, v16, v17
    v_cvt_pk_bf16_f32 v245, v18, v19
    v_cvt_pk_bf16_f32 v246, v20, v21
    v_cvt_pk_bf16_f32 v247, v22, v23
    ds_write_b128 v4, v[240:243] offset:2048
    ds_write_b128 v4, v[244:247] offset:3072
    s_waitcnt vmcnt(15)
    v_mfma_f32_32x32x16_bf16 v[192:207], v[128:131], v[64:67], 0
    buffer_load_dwordx4 v[128:131], v1, s[12:15], s24 offen offset:0
    s_waitcnt vmcnt(15)
    v_mfma_f32_32x32x16_bf16 v[192:207], v[132:135], v[68:71], v[192:207]
    buffer_load_dwordx4 v[132:135], v1, s[12:15], s24 offen offset:1024
    s_waitcnt vmcnt(15)
    v_mfma_f32_32x32x16_bf16 v[192:207], v[136:139], v[72:75], v[192:207]
    buffer_load_dwordx4 v[136:139], v1, s[12:15], s24 offen offset:2048
    s_waitcnt vmcnt(15)
    v_mfma_f32_32x32x16_bf16 v[192:207], v[140:143], v[76:79], v[192:207]
    buffer_load_dwordx4 v[140:143], v1, s[12:15], s24 offen offset:3072
    s_add_u32 s24, s24, 4096
    s_waitcnt vmcnt(15)
    v_mfma_f32_32x32x16_bf16 v[192:207], v[144:147], v[80:83], v[192:207]
    buffer_load_dwordx4 v[144:147], v1, s[12:15], s24 offen offset:0
    s_waitcnt vmcnt(15)
    v_mfma_f32_32x32x16_bf16 v[192:207], v[148:151], v[84:87], v[192:207]
    buffer_load_dwordx4 v[148:151], v1, s[12:15], s24 offen offset:1024
    s_waitcnt vmcnt(15)
    v_mfma_f32_32x32x16_bf16 v[192:207], v[152:155], v[88:91], v[192:207]
    buffer_load_dwordx4 v[152:155], v1, s[12:15], s24 offen offset:2048
    s_waitcnt vmcnt(15)
    v_mfma_f32_32x32x16_bf16 v[192:207], v[156:159], v[92:95], v[192:207]
    buffer_load_dwordx4 v[156:159], v1, s[12:15], s24 offen offset:3072
    s_add_u32 s24, s24, 4096
    s_waitcnt vmcnt(15)
    v_mfma_f32_32x32x16_bf16 v[192:207], v[160:163], v[96:99], v[192:207]
    buffer_load_dwordx4 v[160:163], v1, s[12:15], s24 offen offset:0
    s_waitcnt vmcnt(15)
    v_mfma_f32_32x32x16_bf16 v[192:207], v[164:167], v[100:103], v[192:207]
    buffer_load_dwordx4 v[164:167], v1, s[12:15], s24 offen offset:1024
    s_waitcnt vmcnt(15)
    v_mfma_f32_32x32x16_bf16 v[192:207], v[168:171], v[104:107], v[192:207]
    buffer_load_dwordx4 v[168:171], v1, s[12:15], s24 offen offset:2048
    s_waitcnt vmcnt(15)
    v_mfma_f32_32x32x16_bf16 v[192:207], v[172:175], v[108:111], v[192:207]
    buffer_load_dwordx4 v[172:175], v1, s[12:15], s24 offen offset:3072
    s_add_u32 s24, s24, 4096
    s_waitcnt vmcnt(15)
    v_mfma_f32_32x32x16_bf16 v[192:207], v[176:179], v[112:115], v[192:207]
    buffer_load_dwordx4 v[176:179], v1, s[12:15], s24 offen offset:0
    s_waitcnt vmcnt(15)
    v_mfma_f32_32x32x16_bf16 v[192:207], v[180:183], v[116:119], v[192:207]
    buffer_load_dwordx4 v[180:183], v1, s[12:15], s24 offen offset:1024
    s_waitcnt vmcnt(15)
    v_mfma_f32_32x32x16_bf16 v[192:207], v[184:187], v[120:123], v[192:207]
    buffer_load_dwordx4 v[184:187], v1, s[12:15], s24 offen offset:2048
    s_waitcnt vmcnt(15)
    v_mfma_f32_32x32x16_bf16 v[192:207], v[188:191], v[124:127], v[192:207]
    buffer_load_dwordx4 v[188:191], v1, s[12:15], s24 offen offset:3072
    s_add_u32 s24, s24, 4096
    s_nop 9
    v_cvt_pk_bf16_f32 v40, v192, v193
    v_cvt_pk_bf16_f32 v41, v194, v195
    v_cvt_pk_bf16_f32 v42, v196, v197
    v_cvt_pk_bf16_f32 v43, v198, v199
    v_cvt_pk_bf16_f32 v44, v200, v201
    v_cvt_pk_bf16_f32 v45, v202, v203
    v_cvt_pk_bf16_f32 v46, v204, v205
    v_cvt_pk_bf16_f32 v47, v206, v207
    v_lshlrev_b32 v8, 16, v40
    v_and_b32 v9, 0xffff0000, v40
    v_lshlrev_b32 v10, 16, v41
    v_and_b32 v11, 0xffff0000, v41
    v_lshlrev_b32 v12, 16, v42
    v_and_b32 v13, 0xffff0000, v42
    v_lshlrev_b32 v14, 16, v43
    v_and_b32 v15, 0xffff0000, v43
    v_lshlrev_b32 v16, 16, v44
    v_and_b32 v17, 0xffff0000, v44
    v_lshlrev_b32 v18, 16, v45
    v_and_b32 v19, 0xffff0000, v45
    v_lshlrev_b32 v20, 16, v46
    v_and_b32 v21, 0xffff0000, v46
    v_lshlrev_b32 v22, 16, v47
    v_and_b32 v23, 0xffff0000, v47
    v_mul_f32 v24, 0xbfb8aa3b, v8
    v_mul_f32 v25, 0xbfb8aa3b, v9
    v_mul_f32 v26, 0xbfb8aa3b, v10
    v_mul_f32 v27, 0xbfb8aa3b, v11
    v_mul_f32 v28, 0xbfb8aa3b, v12
    v_mul_f32 v29, 0xbfb8aa3b, v13
    v_mul_f32 v30, 0xbfb8aa3b, v14
    v_mul_f32 v31, 0xbfb8aa3b, v15
    v_mul_f32 v32, 0xbfb8aa3b, v16
    v_mul_f32 v33, 0xbfb8aa3b, v17
    v_mul_f32 v34, 0xbfb8aa3b, v18
    v_mul_f32 v35, 0xbfb8aa3b, v19
    v_mul_f32 v36, 0xbfb8aa3b, v20
    v_mul_f32 v37, 0xbfb8aa3b, v21
    v_mul_f32 v38, 0xbfb8aa3b, v22
    v_mul_f32 v39, 0xbfb8aa3b, v23
    v_exp_f32 v24, v24
    v_exp_f32 v25, v25
    v_exp_f32 v26, v26
    v_exp_f32 v27, v27
    v_exp_f32 v28, v28
    v_exp_f32 v29, v29
    v_exp_f32 v30, v30
    v_exp_f32 v31, v31
    v_exp_f32 v32, v32
    v_exp_f32 v33, v33
    v_exp_f32 v34, v34
    v_exp_f32 v35, v35
    v_exp_f32 v36, v36
    v_exp_f32 v37, v37
    v_exp_f32 v38, v38
    v_exp_f32 v39, v39
    v_add_f32 v24, 1.0, v24
    v_add_f32 v25, 1.0, v25
    v_add_f32 v26, 1.0, v26
    v_add_f32 v27, 1.0, v27
    v_add_f32 v28, 1.0, v28
    v_add_f32 v29, 1.0, v29
    v_add_f32 v30, 1.0, v30
    v_add_f32 v31, 1.0, v31
    v_add_f32 v32, 1.0, v32
    v_add_f32 v33, 1.0, v33
    v_add_f32 v34, 1.0, v34
    v_add_f32 v35, 1.0, v35
    v_add_f32 v36, 1.0, v36
    v_add_f32 v37, 1.0, v37
    v_add_f32 v38, 1.0, v38
    v_add_f32 v39, 1.0, v39
    v_rcp_f32 v24, v24
    v_rcp_f32 v25, v25
    v_rcp_f32 v26, v26
    v_rcp_f32 v27, v27
    v_rcp_f32 v28, v28
    v_rcp_f32 v29, v29
    v_rcp_f32 v30, v30
    v_rcp_f32 v31, v31
    v_rcp_f32 v32, v32
    v_rcp_f32 v33, v33
    v_rcp_f32 v34, v34
    v_rcp_f32 v35, v35
    v_rcp_f32 v36, v36
    v_rcp_f32 v37, v37
    v_rcp_f32 v38, v38
    v_rcp_f32 v39, v39
    v_mul_f32 v8, v8, v24
    v_mul_f32 v9, v9, v25
    v_mul_f32 v10, v10, v26
    v_mul_f32 v11, v11, v27
    v_mul_f32 v12, v12, v28
    v_mul_f32 v13, v13, v29
    v_mul_f32 v14, v14, v30
    v_mul_f32 v15, v15, v31
    v_mul_f32 v16, v16, v32
    v_mul_f32 v17, v17, v33
    v_mul_f32 v18, v18, v34
    v_mul_f32 v19, v19, v35
    v_mul_f32 v20, v20, v36
    v_mul_f32 v21, v21, v37
    v_mul_f32 v22, v22, v38
    v_mul_f32 v23, v23, v39
    v_cvt_pk_bf16_f32 v240, v8, v9
    v_cvt_pk_bf16_f32 v241, v10, v11
    v_cvt_pk_bf16_f32 v242, v12, v13
    v_cvt_pk_bf16_f32 v243, v14, v15
    v_cvt_pk_bf16_f32 v244, v16, v17
    v_cvt_pk_bf16_f32 v245, v18, v19
    v_cvt_pk_bf16_f32 v246, v20, v21
    v_cvt_pk_bf16_f32 v247, v22, v23
    ds_write_b128 v4, v[240:243] offset:4096
    ds_write_b128 v4, v[244:247] offset:5120
    s_waitcnt vmcnt(15)
    v_mfma_f32_32x32x16_bf16 v[208:223], v[128:131], v[64:67], 0
    buffer_load_dwordx4 v[128:131], v1, s[12:15], s24 offen offset:0
    s_waitcnt vmcnt(15)
    v_mfma_f32_32x32x16_bf16 v[208:223], v[132:135], v[68:71], v[208:223]
    buffer_load_dwordx4 v[132:135], v1, s[12:15], s24 offen offset:1024
    s_waitcnt vmcnt(15)
    v_mfma_f32_32x32x16_bf16 v[208:223], v[136:139], v[72:75], v[208:223]
    buffer_load_dwordx4 v[136:139], v1, s[12:15], s24 offen offset:2048
    s_waitcnt vmcnt(15)
    v_mfma_f32_32x32x16_bf16 v[208:223], v[140:143], v[76:79], v[208:223]
    buffer_load_dwordx4 v[140:143], v1, s[12:15], s24 offen offset:3072
    s_add_u32 s24, s24, 4096
    s_waitcnt vmcnt(15)
    v_mfma_f32_32x32x16_bf16 v[208:223], v[144:147], v[80:83], v[208:223]
    buffer_load_dwordx4 v[144:147], v1, s[12:15], s24 offen offset:0
    s_waitcnt vmcnt(15)
    v_mfma_f32_32x32x16_bf16 v[208:223], v[148:151], v[84:87], v[208:223]
    buffer_load_dwordx4 v[148:151], v1, s[12:15], s24 offen offset:1024
    s_waitcnt vmcnt(15)
    v_mfma_f32_32x32x16_bf16 v[208:223], v[152:155], v[88:91], v[208:223]
    buffer_load_dwordx4 v[152:155], v1, s[12:15], s24 offen offset:2048
    s_waitcnt vmcnt(15)
    v_mfma_f32_32x32x16_bf16 v[208:223], v[156:159], v[92:95], v[208:223]
    buffer_load_dwordx4 v[156:159], v1, s[12:15], s24 offen offset:3072
    s_add_u32 s24, s24, 4096
    s_waitcnt vmcnt(15)
    v_mfma_f32_32x32x16_bf16 v[208:223], v[160:163], v[96:99], v[208:223]
    buffer_load_dwordx4 v[160:163], v1, s[12:15], s24 offen offset:0
    s_waitcnt vmcnt(15)
    v_mfma_f32_32x32x16_bf16 v[208:223], v[164:167], v[100:103], v[208:223]
    buffer_load_dwordx4 v[164:167], v1, s[12:15], s24 offen offset:1024
    s_waitcnt vmcnt(15)
    v_mfma_f32_32x32x16_bf16 v[208:223], v[168:171], v[104:107], v[208:223]
    buffer_load_dwordx4 v[168:171], v1, s[12:15], s24 offen offset:2048
    s_waitcnt vmcnt(15)
    v_mfma_f32_32x32x16_bf16 v[208:223], v[172:175], v[108:111], v[208:223]
    buffer_load_dwordx4 v[172:175], v1, s[12:15], s24 offen offset:3072
    s_add_u32 s24, s24, 4096
    s_waitcnt vmcnt(15)
    v_mfma_f32_32x32x16_bf16 v[208:223], v[176:179], v[112:115], v[208:223]
    buffer_load_dwordx4 v[176:179], v1, s[12:15], s24 offen offset:0
    s_waitcnt vmcnt(15)
    v_mfma_f32_32x32x16_bf16 v[208:223], v[180:183], v[116:119], v[208:223]
    buffer_load_dwordx4 v[180:183], v1, s[12:15], s24 offen offset:1024
    s_waitcnt vmcnt(15)
    v_mfma_f32_32x32x16_bf16 v[208:223], v[184:187], v[120:123], v[208:223]
    buffer_load_dwordx4 v[184:187], v1, s[12:15], s24 offen offset:2048
    s_waitcnt vmcnt(15)
    v_mfma_f32_32x32x16_bf16 v[208:223], v[188:191], v[124:127], v[208:223]
    buffer_load_dwordx4 v[188:191], v1, s[12:15], s24 offen offset:3072
    s_add_u32 s24, s24, 4096
    s_nop 9
    v_cvt_pk_bf16_f32 v40, v208, v209
    v_cvt_pk_bf16_f32 v41, v210, v211
    v_cvt_pk_bf16_f32 v42, v212, v213
    v_cvt_pk_bf16_f32 v43, v214, v215
    v_cvt_pk_bf16_f32 v44, v216, v217
    v_cvt_pk_bf16_f32 v45, v218, v219
    v_cvt_pk_bf16_f32 v46, v220, v221
    v_cvt_pk_bf16_f32 v47, v222, v223
    v_lshlrev_b32 v8, 16, v40
    v_and_b32 v9, 0xffff0000, v40
    v_lshlrev_b32 v10, 16, v41
    v_and_b32 v11, 0xffff0000, v41
    v_lshlrev_b32 v12, 16, v42
    v_and_b32 v13, 0xffff0000, v42
    v_lshlrev_b32 v14, 16, v43
    v_and_b32 v15, 0xffff0000, v43
    v_lshlrev_b32 v16, 16, v44
    v_and_b32 v17, 0xffff0000, v44
    v_lshlrev_b32 v18, 16, v45
    v_and_b32 v19, 0xffff0000, v45
    v_lshlrev_b32 v20, 16, v46
    v_and_b32 v21, 0xffff0000, v46
    v_lshlrev_b32 v22, 16, v47
    v_and_b32 v23, 0xffff0000, v47
    v_mul_f32 v24, 0xbfb8aa3b, v8
    v_mul_f32 v25, 0xbfb8aa3b, v9
    v_mul_f32 v26, 0xbfb8aa3b, v10
    v_mul_f32 v27, 0xbfb8aa3b, v11
    v_mul_f32 v28, 0xbfb8aa3b, v12
    v_mul_f32 v29, 0xbfb8aa3b, v13
    v_mul_f32 v30, 0xbfb8aa3b, v14
    v_mul_f32 v31, 0xbfb8aa3b, v15
    v_mul_f32 v32, 0xbfb8aa3b, v16
    v_mul_f32 v33, 0xbfb8aa3b, v17
    v_mul_f32 v34, 0xbfb8aa3b, v18
    v_mul_f32 v35, 0xbfb8aa3b, v19
    v_mul_f32 v36, 0xbfb8aa3b, v20
    v_mul_f32 v37, 0xbfb8aa3b, v21
    v_mul_f32 v38, 0xbfb8aa3b, v22
    v_mul_f32 v39, 0xbfb8aa3b, v23
    v_exp_f32 v24, v24
    v_exp_f32 v25, v25
    v_exp_f32 v26, v26
    v_exp_f32 v27, v27
    v_exp_f32 v28, v28
    v_exp_f32 v29, v29
    v_exp_f32 v30, v30
    v_exp_f32 v31, v31
    v_exp_f32 v32, v32
    v_exp_f32 v33, v33
    v_exp_f32 v34, v34
    v_exp_f32 v35, v35
    v_exp_f32 v36, v36
    v_exp_f32 v37, v37
    v_exp_f32 v38, v38
    v_exp_f32 v39, v39
    v_add_f32 v24, 1.0, v24
    v_add_f32 v25, 1.0, v25
    v_add_f32 v26, 1.0, v26
    v_add_f32 v27, 1.0, v27
    v_add_f32 v28, 1.0, v28
    v_add_f32 v29, 1.0, v29
    v_add_f32 v30, 1.0, v30
    v_add_f32 v31, 1.0, v31
    v_add_f32 v32, 1.0, v32
    v_add_f32 v33, 1.0, v33
    v_add_f32 v34, 1.0, v34
    v_add_f32 v35, 1.0, v35
    v_add_f32 v36, 1.0, v36
    v_add_f32 v37, 1.0, v37
    v_add_f32 v38, 1.0, v38
    v_add_f32 v39, 1.0, v39
    v_rcp_f32 v24, v24
    v_rcp_f32 v25, v25
    v_rcp_f32 v26, v26
    v_rcp_f32 v27, v27
    v_rcp_f32 v28, v28
    v_rcp_f32 v29, v29
    v_rcp_f32 v30, v30
    v_rcp_f32 v31, v31
    v_rcp_f32 v32, v32
    v_rcp_f32 v33, v33
    v_rcp_f32 v34, v34
    v_rcp_f32 v35, v35
    v_rcp_f32 v36, v36
    v_rcp_f32 v37, v37
    v_rcp_f32 v38, v38
    v_rcp_f32 v39, v39
    v_mul_f32 v8, v8, v24
    v_mul_f32 v9, v9, v25
    v_mul_f32 v10, v10, v26
    v_mul_f32 v11, v11, v27
    v_mul_f32 v12, v12, v28
    v_mul_f32 v13, v13, v29
    v_mul_f32 v14, v14, v30
    v_mul_f32 v15, v15, v31
    v_mul_f32 v16, v16, v32
    v_mul_f32 v17, v17, v33
    v_mul_f32 v18, v18, v34
    v_mul_f32 v19, v19, v35
    v_mul_f32 v20, v20, v36
    v_mul_f32 v21, v21, v37
    v_mul_f32 v22, v22, v38
    v_mul_f32 v23, v23, v39
    v_cvt_pk_bf16_f32 v240, v8, v9
    v_cvt_pk_bf16_f32 v241, v10, v11
    v_cvt_pk_bf16_f32 v242, v12, v13
    v_cvt_pk_bf16_f32 v243, v14, v15
    v_cvt_pk_bf16_f32 v244, v16, v17
    v_cvt_pk_bf16_f32 v245, v18, v19
    v_cvt_pk_bf16_f32 v246, v20, v21
    v_cvt_pk_bf16_f32 v247, v22, v23
    ds_write_b128 v4, v[240:243] offset:6144
    ds_write_b128 v4, v[244:247] offset:7168
    s_waitcnt lgkmcnt(0)
    s_barrier
    ds_read_b128 v[64:67], v1 offset:0
    ds_read_b128 v[68:71], v1 offset:1024
    ds_read_b128 v[72:75], v1 offset:2048
    ds_read_b128 v[76:79], v1 offset:3072
    ds_read_b128 v[80:83], v1 offset:4096
    ds_read_b128 v[84:87], v1 offset:5120
    ds_read_b128 v[88:91], v1 offset:6144
    ds_read_b128 v[92:95], v1 offset:7168
    s_waitcnt vmcnt(15) lgkmcnt(7)
    v_mfma_f32_32x32x16_bf16 v[192:207], v[128:131], v[64:67], 0
    buffer_load_dwordx4 v[128:131], v1, s[12:15], s24 offen offset:0
    ds_read_b128 v[64:67], v1 offset:8192
    s_waitcnt vmcnt(15) lgkmcnt(7)
    v_mfma_f32_32x32x16_bf16 v[192:207], v[132:135], v[68:71], v[192:207]
    buffer_load_dwordx4 v[132:135], v1, s[12:15], s24 offen offset:1024
    ds_read_b128 v[68:71], v1 offset:9216
    s_waitcnt vmcnt(15) lgkmcnt(7)
    v_mfma_f32_32x32x16_bf16 v[192:207], v[136:139], v[72:75], v[192:207]
    buffer_load_dwordx4 v[136:139], v1, s[12:15], s24 offen offset:2048
    ds_read_b128 v[72:75], v1 offset:10240
    s_waitcnt vmcnt(15) lgkmcnt(7)
    v_mfma_f32_32x32x16_bf16 v[192:207], v[140:143], v[76:79], v[192:207]
    buffer_load_dwordx4 v[140:143], v1, s[12:15], s24 offen offset:3072
    s_add_u32 s24, s24, 4096
    ds_read_b128 v[76:79], v1 offset:11264
    s_waitcnt vmcnt(15) lgkmcnt(7)
    v_mfma_f32_32x32x16_bf16 v[192:207], v[144:147], v[80:83], v[192:207]
    buffer_load_dwordx4 v[144:147], v1, s[12:15], s24 offen offset:0
    ds_read_b128 v[80:83], v1 offset:12288
    s_waitcnt vmcnt(15) lgkmcnt(7)
    v_mfma_f32_32x32x16_bf16 v[192:207], v[148:151], v[84:87], v[192:207]
    buffer_load_dwordx4 v[148:151], v1, s[12:15], s24 offen offset:1024
    ds_read_b128 v[84:87], v1 offset:13312
    s_waitcnt vmcnt(15) lgkmcnt(7)
    v_mfma_f32_32x32x16_bf16 v[192:207], v[152:155], v[88:91], v[192:207]
    buffer_load_dwordx4 v[152:155], v1, s[12:15], s24 offen offset:2048
    ds_read_b128 v[88:91], v1 offset:14336
    s_waitcnt vmcnt(15) lgkmcnt(7)
    v_mfma_f32_32x32x16_bf16 v[192:207], v[156:159], v[92:95], v[192:207]
    buffer_load_dwordx4 v[156:159], v1, s[12:15], s24 offen offset:3072
    s_add_u32 s24, s24, 4096
    ds_read_b128 v[92:95], v1 offset:15360
    s_waitcnt vmcnt(15) lgkmcnt(7)
    v_mfma_f32_32x32x16_bf16 v[192:207], v[160:163], v[64:67], v[192:207]
    buffer_load_dwordx4 v[160:163], v1, s[12:15], s24 offen offset:0
    ds_read_b128 v[64:67], v1 offset:16384
    s_waitcnt vmcnt(15) lgkmcnt(7)
    v_mfma_f32_32x32x16_bf16 v[192:207], v[164:167], v[68:71], v[192:207]
    buffer_load_dwordx4 v[164:167], v1, s[12:15], s24 offen offset:1024
    ds_read_b128 v[68:71], v1 offset:17408
    s_waitcnt vmcnt(15) lgkmcnt(7)
    v_mfma_f32_32x32x16_bf16 v[192:207], v[168:171], v[72:75], v[192:207]
    buffer_load_dwordx4 v[168:171], v1, s[12:15], s24 offen offset:2048
    ds_read_b128 v[72:75], v1 offset:18432
    s_waitcnt vmcnt(15) lgkmcnt(7)
    v_mfma_f32_32x32x16_bf16 v[192:207], v[172:175], v[76:79], v[192:207]
    buffer_load_dwordx4 v[172:175], v1, s[12:15], s24 offen offset:3072
    s_add_u32 s24, s24, 4096
    ds_read_b128 v[76:79], v1 offset:19456
    s_waitcnt vmcnt(15) lgkmcnt(7)
    v_mfma_f32_32x32x16_bf16 v[192:207], v[176:179], v[80:83], v[192:207]
    buffer_load_dwordx4 v[176:179], v1, s[12:15], s24 offen offset:0
    ds_read_b128 v[80:83], v1 offset:20480
    s_waitcnt vmcnt(15) lgkmcnt(7)
    v_mfma_f32_32x32x16_bf16 v[192:207], v[180:183], v[84:87], v[192:207]
    buffer_load_dwordx4 v[180:183], v1, s[12:15], s24 offen offset:1024
    ds_read_b128 v[84:87], v1 offset:21504
    s_waitcnt vmcnt(15) lgkmcnt(7)
    v_mfma_f32_32x32x16_bf16 v[192:207], v[184:187], v[88:91], v[192:207]
    buffer_load_dwordx4 v[184:187], v1, s[12:15], s24 offen offset:2048
    ds_read_b128 v[88:91], v1 offset:22528
    s_waitcnt vmcnt(15) lgkmcnt(7)
    v_mfma_f32_32x32x16_bf16 v[192:207], v[188:191], v[92:95], v[192:207]
    buffer_load_dwordx4 v[188:191], v1, s[12:15], s24 offen offset:3072
    s_add_u32 s24, s24, 4096
    ds_read_b128 v[92:95], v1 offset:23552
    s_waitcnt vmcnt(15) lgkmcnt(7)
    v_mfma_f32_32x32x16_bf16 v[192:207], v[128:131], v[64:67], v[192:207]
    buffer_load_dwordx4 v[128:131], v1, s[12:15], s24 offen offset:0
    ds_read_b128 v[64:67], v1 offset:24576
    s_waitcnt vmcnt(15) lgkmcnt(7)
    v_mfma_f32_32x32x16_bf16 v[192:207], v[132:135], v[68:71], v[192:207]
    buffer_load_dwordx4 v[132:135], v1, s[12:15], s24 offen offset:1024
    ds_read_b128 v[68:71], v1 offset:25600
    s_waitcnt vmcnt(15) lgkmcnt(7)
    v_mfma_f32_32x32x16_bf16 v[192:207], v[136:139], v[72:75], v[192:207]
    buffer_load_dwordx4 v[136:139], v1, s[12:15], s24 offen offset:2048
    ds_read_b128 v[72:75], v1 offset:26624
    s_waitcnt vmcnt(15) lgkmcnt(7)
    v_mfma_f32_32x32x16_bf16 v[192:207], v[140:143], v[76:79], v[192:207]
    buffer_load_dwordx4 v[140:143], v1, s[12:15], s24 offen offset:3072
    s_add_u32 s24, s24, 4096
    ds_read_b128 v[76:79], v1 offset:27648
    s_waitcnt vmcnt(15) lgkmcnt(7)
    v_mfma_f32_32x32x16_bf16 v[192:207], v[144:147], v[80:83], v[192:207]
    buffer_load_dwordx4 v[144:147], v1, s[12:15], s24 offen offset:0
    ds_read_b128 v[80:83], v1 offset:28672
    s_waitcnt vmcnt(15) lgkmcnt(7)
    v_mfma_f32_32x32x16_bf16 v[192:207], v[148:151], v[84:87], v[192:207]
    buffer_load_dwordx4 v[148:151], v1, s[12:15], s24 offen offset:1024
    ds_read_b128 v[84:87], v1 offset:29696
    s_waitcnt vmcnt(15) lgkmcnt(7)
    v_mfma_f32_32x32x16_bf16 v[192:207], v[152:155], v[88:91], v[192:207]
    buffer_load_dwordx4 v[152:155], v1, s[12:15], s24 offen offset:2048
    ds_read_b128 v[88:91], v1 offset:30720
    s_waitcnt vmcnt(15) lgkmcnt(7)
    v_mfma_f32_32x32x16_bf16 v[192:207], v[156:159], v[92:95], v[192:207]
    buffer_load_dwordx4 v[156:159], v1, s[12:15], s24 offen offset:3072
    s_add_u32 s24, s24, 4096
    ds_read_b128 v[92:95], v1 offset:31744
    s_waitcnt vmcnt(15) lgkmcnt(7)
    v_mfma_f32_32x32x16_bf16 v[192:207], v[160:163], v[64:67], v[192:207]
    buffer_load_dwordx4 v[160:163], v1, s[12:15], s24 offen offset:0
    ds_read_b128 v[64:67], v1 offset:32768
    s_waitcnt vmcnt(15) lgkmcnt(7)
    v_mfma_f32_32x32x16_bf16 v[192:207], v[164:167], v[68:71], v[192:207]
    buffer_load_dwordx4 v[164:167], v1, s[12:15], s24 offen offset:1024
    ds_read_b128 v[68:71], v1 offset:33792
    s_waitcnt vmcnt(15) lgkmcnt(7)
    v_mfma_f32_32x32x16_bf16 v[192:207], v[168:171], v[72:75], v[192:207]
    buffer_load_dwordx4 v[168:171], v1, s[12:15], s24 offen offset:2048
    ds_read_b128 v[72:75], v1 offset:34816
    s_waitcnt vmcnt(15) lgkmcnt(7)
    v_mfma_f32_32x32x16_bf16 v[192:207], v[172:175], v[76:79], v[192:207]
    buffer_load_dwordx4 v[172:175], v1, s[12:15], s24 offen offset:3072
    s_add_u32 s24, s24, 4096
    ds_read_b128 v[76:79], v1 offset:35840
    s_waitcnt vmcnt(15) lgkmcnt(7)
    v_mfma_f32_32x32x16_bf16 v[192:207], v[176:179], v[80:83], v[192:207]
    buffer_load_dwordx4 v[176:179], v1, s[12:15], s24 offen offset:0
    ds_read_b128 v[80:83], v1 offset:36864
    s_waitcnt vmcnt(15) lgkmcnt(7)
    v_mfma_f32_32x32x16_bf16 v[192:207], v[180:183], v[84:87], v[192:207]
    buffer_load_dwordx4 v[180:183], v1, s[12:15], s24 offen offset:1024
    ds_read_b128 v[84:87], v1 offset:37888
    s_waitcnt vmcnt(15) lgkmcnt(7)
    v_mfma_f32_32x32x16_bf16 v[192:207], v[184:187], v[88:91], v[192:207]
    buffer_load_dwordx4 v[184:187], v1, s[12:15], s24 offen offset:2048
    ds_read_b128 v[88:91], v1 offset:38912
    s_waitcnt vmcnt(15) lgkmcnt(7)
    v_mfma_f32_32x32x16_bf16 v[192:207], v[188:191], v[92:95], v[192:207]
    buffer_load_dwordx4 v[188:191], v1, s[12:15], s24 offen offset:3072
    s_add_u32 s24, s24, 4096
    ds_read_b128 v[92:95], v1 offset:39936
    s_waitcnt vmcnt(15) lgkmcnt(7)
    v_mfma_f32_32x32x16_bf16 v[192:207], v[128:131], v[64:67], v[192:207]
    buffer_load_dwordx4 v[128:131], v1, s[12:15], s24 offen offset:0
    ds_read_b128 v[64:67], v1 offset:40960
    s_waitcnt vmcnt(15) lgkmcnt(7)
    v_mfma_f32_32x32x16_bf16 v[192:207], v[132:135], v[68:71], v[192:207]
    buffer_load_dwordx4 v[132:135], v1, s[12:15], s24 offen offset:1024
    ds_read_b128 v[68:71], v1 offset:41984
    s_waitcnt vmcnt(15) lgkmcnt(7)
    v_mfma_f32_32x32x16_bf16 v[192:207], v[136:139], v[72:75], v[192:207]
    buffer_load_dwordx4 v[136:139], v1, s[12:15], s24 offen offset:2048
    ds_read_b128 v[72:75], v1 offset:43008
    s_waitcnt vmcnt(15) lgkmcnt(7)
    v_mfma_f32_32x32x16_bf16 v[192:207], v[140:143], v[76:79], v[192:207]
    buffer_load_dwordx4 v[140:143], v1, s[12:15], s24 offen offset:3072
    s_add_u32 s24, s24, 4096
    ds_read_b128 v[76:79], v1 offset:44032
    s_waitcnt vmcnt(15) lgkmcnt(7)
    v_mfma_f32_32x32x16_bf16 v[192:207], v[144:147], v[80:83], v[192:207]
    buffer_load_dwordx4 v[144:147], v1, s[12:15], s24 offen offset:0
    ds_read_b128 v[80:83], v1 offset:45056
    s_waitcnt vmcnt(15) lgkmcnt(7)
    v_mfma_f32_32x32x16_bf16 v[192:207], v[148:151], v[84:87], v[192:207]
    buffer_load_dwordx4 v[148:151], v1, s[12:15], s24 offen offset:1024
    ds_read_b128 v[84:87], v1 offset:46080
    s_waitcnt vmcnt(15) lgkmcnt(7)
    v_mfma_f32_32x32x16_bf16 v[192:207], v[152:155], v[88:91], v[192:207]
    buffer_load_dwordx4 v[152:155], v1, s[12:15], s24 offen offset:2048
    ds_read_b128 v[88:91], v1 offset:47104
    s_waitcnt vmcnt(15) lgkmcnt(7)
    v_mfma_f32_32x32x16_bf16 v[192:207], v[156:159], v[92:95], v[192:207]
    buffer_load_dwordx4 v[156:159], v1, s[12:15], s24 offen offset:3072
    s_add_u32 s24, s24, 4096
    ds_read_b128 v[92:95], v1 offset:48128
    s_waitcnt vmcnt(15) lgkmcnt(7)
    v_mfma_f32_32x32x16_bf16 v[192:207], v[160:163], v[64:67], v[192:207]
    buffer_load_dwordx4 v[160:163], v1, s[12:15], s24 offen offset:0
    ds_read_b128 v[64:67], v1 offset:49152
    s_waitcnt vmcnt(15) lgkmcnt(7)
    v_mfma_f32_32x32x16_bf16 v[192:207], v[164:167], v[68:71], v[192:207]
    buffer_load_dwordx4 v[164:167], v1, s[12:15], s24 offen offset:1024
    ds_read_b128 v[68:71], v1 offset:50176
    s_waitcnt vmcnt(15) lgkmcnt(7)
    v_mfma_f32_32x32x16_bf16 v[192:207], v[168:171], v[72:75], v[192:207]
    buffer_load_dwordx4 v[168:171], v1, s[12:15], s24 offen offset:2048
    ds_read_b128 v[72:75], v1 offset:51200
    s_waitcnt vmcnt(15) lgkmcnt(7)
    v_mfma_f32_32x32x16_bf16 v[192:207], v[172:175], v[76:79], v[192:207]
    buffer_load_dwordx4 v[172:175], v1, s[12:15], s24 offen offset:3072
    s_add_u32 s24, s24, 4096
    ds_read_b128 v[76:79], v1 offset:52224
    s_waitcnt vmcnt(15) lgkmcnt(7)
    v_mfma_f32_32x32x16_bf16 v[192:207], v[176:179], v[80:83], v[192:207]
    buffer_load_dwordx4 v[176:179], v1, s[12:15], s24 offen offset:0
    ds_read_b128 v[80:83], v1 offset:53248
    s_waitcnt vmcnt(15) lgkmcnt(7)
    v_mfma_f32_32x32x16_bf16 v[192:207], v[180:183], v[84:87], v[192:207]
    buffer_load_dwordx4 v[180:183], v1, s[12:15], s24 offen offset:1024
    ds_read_b128 v[84:87], v1 offset:54272
    s_waitcnt vmcnt(15) lgkmcnt(7)
    v_mfma_f32_32x32x16_bf16 v[192:207], v[184:187], v[88:91], v[192:207]
    buffer_load_dwordx4 v[184:187], v1, s[12:15], s24 offen offset:2048
    ds_read_b128 v[88:91], v1 offset:55296
    s_waitcnt vmcnt(15) lgkmcnt(7)
    v_mfma_f32_32x32x16_bf16 v[192:207], v[188:191], v[92:95], v[192:207]
    buffer_load_dwordx4 v[188:191], v1, s[12:15], s24 offen offset:3072
    s_add_u32 s24, s24, 4096
    ds_read_b128 v[92:95], v1 offset:56320
    s_waitcnt vmcnt(15) lgkmcnt(7)
    v_mfma_f32_32x32x16_bf16 v[192:207], v[128:131], v[64:67], v[192:207]
    buffer_load_dwordx4 v[128:131], v1, s[12:15], s24 offen offset:0
    ds_read_b128 v[64:67], v1 offset:57344
    s_waitcnt vmcnt(15) lgkmcnt(7)
    v_mfma_f32_32x32x16_bf16 v[192:207], v[132:135], v[68:71], v[192:207]
    buffer_load_dwordx4 v[132:135], v1, s[12:15], s24 offen offset:1024
    ds_read_b128 v[68:71], v1 offset:58368
    s_waitcnt vmcnt(15) lgkmcnt(7)
    v_mfma_f32_32x32x16_bf16 v[192:207], v[136:139], v[72:75], v[192:207]
    buffer_load_dwordx4 v[136:139], v1, s[12:15], s24 offen offset:2048
    ds_read_b128 v[72:75], v1 offset:59392
    s_waitcnt vmcnt(15) lgkmcnt(7)
    v_mfma_f32_32x32x16_bf16 v[192:207], v[140:143], v[76:79], v[192:207]
    buffer_load_dwordx4 v[140:143], v1, s[12:15], s24 offen offset:3072
    s_add_u32 s24, s24, 4096
    ds_read_b128 v[76:79], v1 offset:60416
    s_waitcnt vmcnt(15) lgkmcnt(7)
    v_mfma_f32_32x32x16_bf16 v[192:207], v[144:147], v[80:83], v[192:207]
    buffer_load_dwordx4 v[144:147], v1, s[12:15], s24 offen offset:0
    ds_read_b128 v[80:83], v1 offset:61440
    s_waitcnt vmcnt(15) lgkmcnt(7)
    v_mfma_f32_32x32x16_bf16 v[192:207], v[148:151], v[84:87], v[192:207]
    buffer_load_dwordx4 v[148:151], v1, s[12:15], s24 offen offset:1024
    ds_read_b128 v[84:87], v1 offset:62464
    s_waitcnt vmcnt(15) lgkmcnt(7)
    v_mfma_f32_32x32x16_bf16 v[192:207], v[152:155], v[88:91], v[192:207]
    buffer_load_dwordx4 v[152:155], v1, s[12:15], s24 offen offset:2048
    ds_read_b128 v[88:91], v1 offset:63488
    s_waitcnt vmcnt(15) lgkmcnt(7)
    v_mfma_f32_32x32x16_bf16 v[192:207], v[156:159], v[92:95], v[192:207]
    buffer_load_dwordx4 v[156:159], v1, s[12:15], s24 offen offset:3072
    s_add_u32 s24, s24, 4096
    ds_read_b128 v[92:95], v1 offset:64512
    s_waitcnt vmcnt(15) lgkmcnt(7)
    v_mfma_f32_32x32x16_bf16 v[192:207], v[160:163], v[64:67], v[192:207]
    buffer_load_dwordx4 v[160:163], v1, s[12:15], s24 offen offset:0
    s_waitcnt vmcnt(15) lgkmcnt(6)
    v_mfma_f32_32x32x16_bf16 v[192:207], v[164:167], v[68:71], v[192:207]
    buffer_load_dwordx4 v[164:167], v1, s[12:15], s24 offen offset:1024
    s_waitcnt vmcnt(15) lgkmcnt(5)
    v_mfma_f32_32x32x16_bf16 v[192:207], v[168:171], v[72:75], v[192:207]
    buffer_load_dwordx4 v[168:171], v1, s[12:15], s24 offen offset:2048
    s_waitcnt vmcnt(15) lgkmcnt(4)
    v_mfma_f32_32x32x16_bf16 v[192:207], v[172:175], v[76:79], v[192:207]
    buffer_load_dwordx4 v[172:175], v1, s[12:15], s24 offen offset:3072
    s_add_u32 s24, s24, 4096
    s_waitcnt vmcnt(15) lgkmcnt(3)
    v_mfma_f32_32x32x16_bf16 v[192:207], v[176:179], v[80:83], v[192:207]
    buffer_load_dwordx4 v[176:179], v1, s[12:15], s24 offen offset:0
    s_waitcnt vmcnt(15) lgkmcnt(2)
    v_mfma_f32_32x32x16_bf16 v[192:207], v[180:183], v[84:87], v[192:207]
    buffer_load_dwordx4 v[180:183], v1, s[12:15], s24 offen offset:1024
    s_waitcnt vmcnt(15) lgkmcnt(1)
    v_mfma_f32_32x32x16_bf16 v[192:207], v[184:187], v[88:91], v[192:207]
    buffer_load_dwordx4 v[184:187], v1, s[12:15], s24 offen offset:2048
    s_waitcnt vmcnt(15) lgkmcnt(0)
    v_mfma_f32_32x32x16_bf16 v[192:207], v[188:191], v[92:95], v[192:207]
    buffer_load_dwordx4 v[188:191], v1, s[12:15], s24 offen offset:3072
    s_add_u32 s24, s24, 4096
    s_nop 9
    v_fma_f32 v8, v192, 0.5, v224
    v_fma_f32 v9, v193, 0.5, v225
    v_fma_f32 v10, v194, 0.5, v226
    v_fma_f32 v11, v195, 0.5, v227
    v_fma_f32 v12, v196, 0.5, v228
    v_fma_f32 v13, v197, 0.5, v229
    v_fma_f32 v14, v198, 0.5, v230
    v_fma_f32 v15, v199, 0.5, v231
    v_fma_f32 v16, v200, 0.5, v232
    v_fma_f32 v17, v201, 0.5, v233
    v_fma_f32 v18, v202, 0.5, v234
    v_fma_f32 v19, v203, 0.5, v235
    v_fma_f32 v20, v204, 0.5, v236
    v_fma_f32 v21, v205, 0.5, v237
    v_fma_f32 v22, v206, 0.5, v238
    v_fma_f32 v23, v207, 0.5, v239
    v_cvt_pk_bf16_f32 v240, v8, v9
    v_cvt_pk_bf16_f32 v241, v10, v11
    v_cvt_pk_bf16_f32 v242, v12, v13
    v_cvt_pk_bf16_f32 v243, v14, v15
    v_cvt_pk_bf16_f32 v244, v16, v17
    v_cvt_pk_bf16_f32 v245, v18, v19
    v_cvt_pk_bf16_f32 v246, v20, v21
    v_cvt_pk_bf16_f32 v247, v22, v23
    v_lshlrev_b32 v224, 16, v240
    v_and_b32 v225, 0xffff0000, v240
    v_lshlrev_b32 v226, 16, v241
    v_and_b32 v227, 0xffff0000, v241
    v_lshlrev_b32 v228, 16, v242
    v_and_b32 v229, 0xffff0000, v242
    v_lshlrev_b32 v230, 16, v243
    v_and_b32 v231, 0xffff0000, v243
    v_lshlrev_b32 v232, 16, v244
    v_and_b32 v233, 0xffff0000, v244
    v_lshlrev_b32 v234, 16, v245
    v_and_b32 v235, 0xffff0000, v245
    v_lshlrev_b32 v236, 16, v246
    v_and_b32 v237, 0xffff0000, v246
    v_lshlrev_b32 v238, 16, v247
    v_and_b32 v239, 0xffff0000, v247
    s_lshl_b32 s25, s29, 14
    s_lshl_b32 s28, s3, 11
    s_add_u32 s25, s25, s28
    s_add_u32 s25, s25, 4194304
    buffer_store_dwordx4 v[240:243], v1, s[12:15], s25 offen
    buffer_store_dwordx4 v[244:247], v1, s[12:15], s25 offen offset:1024
    v_add_f32 v8, v224, v225
    v_add_f32 v9, v226, v227
    v_add_f32 v8, v8, v228
    v_add_f32 v9, v9, v229
    v_add_f32 v8, v8, v230
    v_add_f32 v9, v9, v231
    v_add_f32 v8, v8, v232
    v_add_f32 v9, v9, v233
    v_add_f32 v8, v8, v234
    v_add_f32 v9, v9, v235
    v_add_f32 v8, v8, v236
    v_add_f32 v9, v9, v237
    v_add_f32 v8, v8, v238
    v_add_f32 v9, v9, v239
    v_add_f32 v8, v8, v9
    v_mul_f32 v8, 0x3d800000, v8
    v_sub_f32 v10, v224, v8
    v_mul_f32 v14, v10, v10
    v_sub_f32 v11, v225, v8
    v_mul_f32 v15, v11, v11
    v_sub_f32 v12, v226, v8
    v_fma_f32 v14, v12, v12, v14
    v_sub_f32 v13, v227, v8
    v_fma_f32 v15, v13, v13, v15
    v_sub_f32 v10, v228, v8
    v_fma_f32 v14, v10, v10, v14
    v_sub_f32 v11, v229, v8
    v_fma_f32 v15, v11, v11, v15
    v_sub_f32 v12, v230, v8
    v_fma_f32 v14, v12, v12, v14
    v_sub_f32 v13, v231, v8
    v_fma_f32 v15, v13, v13, v15
    v_sub_f32 v10, v232, v8
    v_fma_f32 v14, v10, v10, v14
    v_sub_f32 v11, v233, v8
    v_fma_f32 v15, v11, v11, v15
    v_sub_f32 v12, v234, v8
    v_fma_f32 v14, v12, v12, v14
    v_sub_f32 v13, v235, v8
    v_fma_f32 v15, v13, v13, v15
    v_sub_f32 v10, v236, v8
    v_fma_f32 v14, v10, v10, v14
    v_sub_f32 v11, v237, v8
    v_fma_f32 v15, v11, v11, v15
    v_sub_f32 v12, v238, v8
    v_fma_f32 v14, v12, v12, v14
    v_sub_f32 v13, v239, v8
    v_fma_f32 v15, v13, v13, v15
    v_add_f32 v9, v14, v15
    ds_write_b64 v5, v[8:9] offset:0
    s_waitcnt lgkmcnt(0)
    s_barrier
    ds_read_b128 v[64:67], v6 offset:0
    ds_read_b128 v[68:71], v6 offset:16
    ds_read_b128 v[72:75], v6 offset:32
    ds_read_b128 v[76:79], v6 offset:48
    ds_read_b128 v[80:83], v6 offset:64
    ds_read_b128 v[84:87], v6 offset:80
    ds_read_b128 v[88:91], v6 offset:96
    ds_read_b128 v[92:95], v6 offset:112
    s_waitcnt lgkmcnt(7)
    v_add_f32 v8, v64, v66
    s_waitcnt lgkmcnt(6)
    v_add_f32 v9, v68, v70
    s_waitcnt lgkmcnt(5)
    v_add_f32 v8, v8, v72
    v_add_f32 v9, v9, v74
    s_waitcnt lgkmcnt(4)
    v_add_f32 v8, v8, v76
    v_add_f32 v9, v9, v78
    s_waitcnt lgkmcnt(3)
    v_add_f32 v8, v8, v80
    v_add_f32 v9, v9, v82
    s_waitcnt lgkmcnt(2)
    v_add_f32 v8, v8, v84
    v_add_f32 v9, v9, v86
    s_waitcnt lgkmcnt(1)
    v_add_f32 v8, v8, v88
    v_add_f32 v9, v9, v90
    s_waitcnt lgkmcnt(0)
    v_add_f32 v8, v8, v92
    v_add_f32 v9, v9, v94
    v_add_f32 v8, v8, v9
    v_mul_f32 v8, 0x3d800000, v8
    v_add_f32 v9, v65, v67
    v_add_f32 v10, v69, v71
    v_add_f32 v9, v9, v73
    v_add_f32 v10, v10, v75
    v_add_f32 v9, v9, v77
    v_add_f32 v10, v10, v79
    v_add_f32 v9, v9, v81
    v_add_f32 v10, v10, v83
    v_add_f32 v9, v9, v85
    v_add_f32 v10, v10, v87
    v_add_f32 v9, v9, v89
    v_add_f32 v10, v10, v91
    v_add_f32 v9, v9, v93
    v_add_f32 v10, v10, v95
    v_add_f32 v9, v9, v10
    v_sub_f32 v12, v64, v8
    v_mul_f32 v10, v12, v12
    v_sub_f32 v13, v66, v8
    v_mul_f32 v11, v13, v13
    v_sub_f32 v14, v68, v8
    v_fma_f32 v10, v14, v14, v10
    v_sub_f32 v15, v70, v8
    v_fma_f32 v11, v15, v15, v11
    v_sub_f32 v12, v72, v8
    v_fma_f32 v10, v12, v12, v10
    v_sub_f32 v13, v74, v8
    v_fma_f32 v11, v13, v13, v11
    v_sub_f32 v14, v76, v8
    v_fma_f32 v10, v14, v14, v10
    v_sub_f32 v15, v78, v8
    v_fma_f32 v11, v15, v15, v11
    v_sub_f32 v12, v80, v8
    v_fma_f32 v10, v12, v12, v10
    v_sub_f32 v13, v82, v8
    v_fma_f32 v11, v13, v13, v11
    v_sub_f32 v14, v84, v8
    v_fma_f32 v10, v14, v14, v10
    v_sub_f32 v15, v86, v8
    v_fma_f32 v11, v15, v15, v11
    v_sub_f32 v12, v88, v8
    v_fma_f32 v10, v12, v12, v10
    v_sub_f32 v13, v90, v8
    v_fma_f32 v11, v13, v13, v11
    v_sub_f32 v14, v92, v8
    v_fma_f32 v10, v14, v14, v10
    v_sub_f32 v15, v94, v8
    v_fma_f32 v11, v15, v15, v11
    v_add_f32 v10, v10, v11
    v_mov_b32 v11, 0x41800000
    v_fma_f32 v9, v10, v11, v9
    v_mul_f32 v9, 0x3b800000, v9
    v_cvt_pk_bf16_f32 v10, v8, v9
    v_lshlrev_b32 v8, 16, v10
    v_and_b32 v9, 0xffff0000, v10
    v_add_f32 v9, 0x3727c5ac, v9
    v_cvt_pk_bf16_f32 v9, v9, v9
    v_lshlrev_b32 v9, 16, v9
    v_sqrt_f32 v9, v9
    s_nop 0
    v_cvt_pk_bf16_f32 v9, v9, v9
    v_lshlrev_b32 v9, 16, v9
    v_rcp_f32 v9, v9
    v_sub_f32 v10, v224, v8
    v_sub_f32 v11, v225, v8
    v_sub_f32 v12, v226, v8
    v_sub_f32 v13, v227, v8
    v_sub_f32 v14, v228, v8
    v_sub_f32 v15, v229, v8
    v_sub_f32 v16, v230, v8
    v_sub_f32 v17, v231, v8
    v_sub_f32 v18, v232, v8
    v_sub_f32 v19, v233, v8
    v_sub_f32 v20, v234, v8
    v_sub_f32 v21, v235, v8
    v_sub_f32 v22, v236, v8
    v_sub_f32 v23, v237, v8
    v_sub_f32 v24, v238, v8
    v_sub_f32 v25, v239, v8
    v_mul_f32 v10, v10, v9
    v_mul_f32 v11, v11, v9
    v_mul_f32 v12, v12, v9
    v_mul_f32 v13, v13, v9
    v_mul_f32 v14, v14, v9
    v_mul_f32 v15, v15, v9
    v_mul_f32 v16, v16, v9
    v_mul_f32 v17, v17, v9
    v_mul_f32 v18, v18, v9
    v_mul_f32 v19, v19, v9
    v_mul_f32 v20, v20, v9
    v_mul_f32 v21, v21, v9
    v_mul_f32 v22, v22, v9
    v_mul_f32 v23, v23, v9
    v_mul_f32 v24, v24, v9
    v_mul_f32 v25, v25, v9
    v_cvt_pk_bf16_f32 v240, v10, v11
    v_cvt_pk_bf16_f32 v241, v12, v13
    v_cvt_pk_bf16_f32 v242, v14, v15
    v_cvt_pk_bf16_f32 v243, v16, v17
    v_cvt_pk_bf16_f32 v244, v18, v19
    v_cvt_pk_bf16_f32 v245, v20, v21
    v_cvt_pk_bf16_f32 v246, v22, v23
    v_cvt_pk_bf16_f32 v247, v24, v25
    ds_write_b128 v3, v[240:243]
    ds_write_b128 v3, v[244:247] offset:1024
    s_waitcnt lgkmcnt(0)
    s_barrier
    ds_read_b128 v[64:67], v2 offset:0
    ds_read_b128 v[68:71], v2 offset:1024
    ds_read_b128 v[72:75], v2 offset:2048
    ds_read_b128 v[76:79], v2 offset:3072
    ds_read_b128 v[80:83], v2 offset:4096
    ds_read_b128 v[84:87], v2 offset:5120
    ds_read_b128 v[88:91], v2 offset:6144
    ds_read_b128 v[92:95], v2 offset:7168
    ds_read_b128 v[96:99], v2 offset:8192
    ds_read_b128 v[100:103], v2 offset:9216
    ds_read_b128 v[104:107], v2 offset:10240
    ds_read_b128 v[108:111], v2 offset:11264
    ds_read_b128 v[112:115], v2 offset:12288
    ds_read_b128 v[116:119], v2 offset:13312
    ds_read_b128 v[120:123], v2 offset:14336
    ds_read_b128 v[124:127], v2 offset:15360
    s_lshl_b32 s25, s30, 2
    s_lshr_b32 s26, s3, 1
    s_add_u32 s25, s25, s26
    s_mul_i32 s25, s25, 125
    s_add_u32 s25, s25, s31
    s_lshl_b32 s25, s25, 12
    s_and_b32 s26, s3, 1
    s_lshl_b32 s26, s26, 11
    s_add_u32 s25, s25, s26
    s_waitcnt vmcnt(17) lgkmcnt(15)
    v_mfma_f32_32x32x16_bf16 v[192:207], v[128:131], v[64:67], 0
    buffer_load_dwordx4 v[128:131], v1, s[12:15], s24 offen offset:0
    s_waitcnt vmcnt(17) lgkmcnt(14)
    v_mfma_f32_32x32x16_bf16 v[192:207], v[132:135], v[68:71], v[192:207]
    buffer_load_dwordx4 v[132:135], v1, s[12:15], s24 offen offset:1024
    s_waitcnt vmcnt(17) lgkmcnt(13)
    v_mfma_f32_32x32x16_bf16 v[192:207], v[136:139], v[72:75], v[192:207]
    buffer_load_dwordx4 v[136:139], v1, s[12:15], s24 offen offset:2048
    s_waitcnt vmcnt(17) lgkmcnt(12)
    v_mfma_f32_32x32x16_bf16 v[192:207], v[140:143], v[76:79], v[192:207]
    buffer_load_dwordx4 v[140:143], v1, s[12:15], s24 offen offset:3072
    s_add_u32 s24, s24, 4096
    s_waitcnt vmcnt(17) lgkmcnt(11)
    v_mfma_f32_32x32x16_bf16 v[192:207], v[144:147], v[80:83], v[192:207]
    buffer_load_dwordx4 v[144:147], v1, s[12:15], s24 offen offset:0
    s_waitcnt vmcnt(17) lgkmcnt(10)
    v_mfma_f32_32x32x16_bf16 v[192:207], v[148:151], v[84:87], v[192:207]
    buffer_load_dwordx4 v[148:151], v1, s[12:15], s24 offen offset:1024
    s_waitcnt vmcnt(17) lgkmcnt(9)
    v_mfma_f32_32x32x16_bf16 v[192:207], v[152:155], v[88:91], v[192:207]
    buffer_load_dwordx4 v[152:155], v1, s[12:15], s24 offen offset:2048
    s_waitcnt vmcnt(17) lgkmcnt(8)
    v_mfma_f32_32x32x16_bf16 v[192:207], v[156:159], v[92:95], v[192:207]
    buffer_load_dwordx4 v[156:159], v1, s[12:15], s24 offen offset:3072
    s_add_u32 s24, s24, 4096
    s_waitcnt vmcnt(17) lgkmcnt(7)
    v_mfma_f32_32x32x16_bf16 v[192:207], v[160:163], v[96:99], v[192:207]
    buffer_load_dwordx4 v[160:163], v1, s[12:15], s24 offen offset:0
    s_waitcnt vmcnt(17) lgkmcnt(6)
    v_mfma_f32_32x32x16_bf16 v[192:207], v[164:167], v[100:103], v[192:207]
    buffer_load_dwordx4 v[164:167], v1, s[12:15], s24 offen offset:1024
    s_waitcnt vmcnt(17) lgkmcnt(5)
    v_mfma_f32_32x32x16_bf16 v[192:207], v[168:171], v[104:107], v[192:207]
    buffer_load_dwordx4 v[168:171], v1, s[12:15], s24 offen offset:2048
    s_waitcnt vmcnt(17) lgkmcnt(4)
    v_mfma_f32_32x32x16_bf16 v[192:207], v[172:175], v[108:111], v[192:207]
    buffer_load_dwordx4 v[172:175], v1, s[12:15], s24 offen offset:3072
    s_add_u32 s24, s24, 4096
    s_waitcnt vmcnt(17) lgkmcnt(3)
    v_mfma_f32_32x32x16_bf16 v[192:207], v[176:179], v[112:115], v[192:207]
    buffer_load_dwordx4 v[176:179], v1, s[12:15], s24 offen offset:0
    s_waitcnt vmcnt(17) lgkmcnt(2)
    v_mfma_f32_32x32x16_bf16 v[192:207], v[180:183], v[116:119], v[192:207]
    buffer_load_dwordx4 v[180:183], v1, s[12:15], s24 offen offset:1024
    s_waitcnt vmcnt(17) lgkmcnt(1)
    v_mfma_f32_32x32x16_bf16 v[192:207], v[184:187], v[120:123], v[192:207]
    buffer_load_dwordx4 v[184:187], v1, s[12:15], s24 offen offset:2048
    s_waitcnt vmcnt(17) lgkmcnt(0)
    v_mfma_f32_32x32x16_bf16 v[192:207], v[188:191], v[124:127], v[192:207]
    buffer_load_dwordx4 v[188:191], v1, s[12:15], s24 offen offset:3072
    s_add_u32 s24, s24, 4096
    s_nop 9
    v_mul_f32 v192, 0x3e38aa3b, v192
    v_mul_f32 v193, 0x3e38aa3b, v193
    v_mul_f32 v194, 0x3e38aa3b, v194
    v_mul_f32 v195, 0x3e38aa3b, v195
    v_mul_f32 v196, 0x3e38aa3b, v196
    v_mul_f32 v197, 0x3e38aa3b, v197
    v_mul_f32 v198, 0x3e38aa3b, v198
    v_mul_f32 v199, 0x3e38aa3b, v199
    v_mul_f32 v200, 0x3e38aa3b, v200
    v_mul_f32 v201, 0x3e38aa3b, v201
    v_mul_f32 v202, 0x3e38aa3b, v202
    v_mul_f32 v203, 0x3e38aa3b, v203
    v_mul_f32 v204, 0x3e38aa3b, v204
    v_mul_f32 v205, 0x3e38aa3b, v205
    v_mul_f32 v206, 0x3e38aa3b, v206
    v_mul_f32 v207, 0x3e38aa3b, v207
    v_cvt_pk_bf16_f32 v240, v192, v193
    v_cvt_pk_bf16_f32 v241, v194, v195
    v_cvt_pk_bf16_f32 v242, v196, v197
    v_cvt_pk_bf16_f32 v243, v198, v199
    v_cvt_pk_bf16_f32 v244, v200, v201
    v_cvt_pk_bf16_f32 v245, v202, v203
    v_cvt_pk_bf16_f32 v246, v204, v205
    v_cvt_pk_bf16_f32 v247, v206, v207
    s_add_u32 s26, s25, 8388608
    buffer_store_dwordx4 v[240:243], v1, s[12:15], s26 offen
    buffer_store_dwordx4 v[244:247], v1, s[12:15], s26 offen offset:1024
    s_waitcnt vmcnt(17)
    v_mfma_f32_32x32x16_bf16 v[208:223], v[128:131], v[64:67], 0
    buffer_load_dwordx4 v[128:131], v1, s[12:15], s24 offen offset:0
    s_waitcnt vmcnt(17)
    v_mfma_f32_32x32x16_bf16 v[208:223], v[132:135], v[68:71], v[208:223]
    buffer_load_dwordx4 v[132:135], v1, s[12:15], s24 offen offset:1024
    s_waitcnt vmcnt(17)
    v_mfma_f32_32x32x16_bf16 v[208:223], v[136:139], v[72:75], v[208:223]
    buffer_load_dwordx4 v[136:139], v1, s[12:15], s24 offen offset:2048
    s_waitcnt vmcnt(17)
    v_mfma_f32_32x32x16_bf16 v[208:223], v[140:143], v[76:79], v[208:223]
    buffer_load_dwordx4 v[140:143], v1, s[12:15], s24 offen offset:3072
    s_add_u32 s24, s24, 4096
    s_waitcnt vmcnt(17)
    v_mfma_f32_32x32x16_bf16 v[208:223], v[144:147], v[80:83], v[208:223]
    buffer_load_dwordx4 v[144:147], v1, s[12:15], s24 offen offset:0
    s_waitcnt vmcnt(17)
    v_mfma_f32_32x32x16_bf16 v[208:223], v[148:151], v[84:87], v[208:223]
    buffer_load_dwordx4 v[148:151], v1, s[12:15], s24 offen offset:1024
    s_waitcnt vmcnt(17)
    v_mfma_f32_32x32x16_bf16 v[208:223], v[152:155], v[88:91], v[208:223]
    buffer_load_dwordx4 v[152:155], v1, s[12:15], s24 offen offset:2048
    s_waitcnt vmcnt(17)
    v_mfma_f32_32x32x16_bf16 v[208:223], v[156:159], v[92:95], v[208:223]
    buffer_load_dwordx4 v[156:159], v1, s[12:15], s24 offen offset:3072
    s_add_u32 s24, s24, 4096
    s_waitcnt vmcnt(17)
    v_mfma_f32_32x32x16_bf16 v[208:223], v[160:163], v[96:99], v[208:223]
    buffer_load_dwordx4 v[160:163], v1, s[12:15], s24 offen offset:0
    s_waitcnt vmcnt(17)
    v_mfma_f32_32x32x16_bf16 v[208:223], v[164:167], v[100:103], v[208:223]
    buffer_load_dwordx4 v[164:167], v1, s[12:15], s24 offen offset:1024
    s_waitcnt vmcnt(17)
    v_mfma_f32_32x32x16_bf16 v[208:223], v[168:171], v[104:107], v[208:223]
    buffer_load_dwordx4 v[168:171], v1, s[12:15], s24 offen offset:2048
    s_waitcnt vmcnt(17)
    v_mfma_f32_32x32x16_bf16 v[208:223], v[172:175], v[108:111], v[208:223]
    buffer_load_dwordx4 v[172:175], v1, s[12:15], s24 offen offset:3072
    s_add_u32 s24, s24, 4096
    s_waitcnt vmcnt(17)
    v_mfma_f32_32x32x16_bf16 v[208:223], v[176:179], v[112:115], v[208:223]
    buffer_load_dwordx4 v[176:179], v1, s[12:15], s24 offen offset:0
    s_waitcnt vmcnt(17)
    v_mfma_f32_32x32x16_bf16 v[208:223], v[180:183], v[116:119], v[208:223]
    buffer_load_dwordx4 v[180:183], v1, s[12:15], s24 offen offset:1024
    s_waitcnt vmcnt(17)
    v_mfma_f32_32x32x16_bf16 v[208:223], v[184:187], v[120:123], v[208:223]
    buffer_load_dwordx4 v[184:187], v1, s[12:15], s24 offen offset:2048
    s_waitcnt vmcnt(17)
    v_mfma_f32_32x32x16_bf16 v[208:223], v[188:191], v[124:127], v[208:223]
    buffer_load_dwordx4 v[188:191], v1, s[12:15], s24 offen offset:3072
    s_add_u32 s24, s24, 4096
    s_nop 9
    v_cvt_pk_bf16_f32 v240, v208, v209
    v_cvt_pk_bf16_f32 v241, v210, v211
    v_cvt_pk_bf16_f32 v242, v212, v213
    v_cvt_pk_bf16_f32 v243, v214, v215
    v_cvt_pk_bf16_f32 v244, v216, v217
    v_cvt_pk_bf16_f32 v245, v218, v219
    v_cvt_pk_bf16_f32 v246, v220, v221
    v_cvt_pk_bf16_f32 v247, v222, v223
    s_add_u32 s26, s25, 12582912
    buffer_store_dwordx4 v[240:243], v1, s[12:15], s26 offen
    buffer_store_dwordx4 v[244:247], v1, s[12:15], s26 offen offset:1024
    s_waitcnt vmcnt(17)
    v_mfma_f32_32x32x16_bf16 v[192:207], v[64:67], v[128:131], 0
    s_waitcnt vmcnt(16)
    v_mfma_f32_32x32x16_bf16 v[192:207], v[68:71], v[132:135], v[192:207]
    s_waitcnt vmcnt(15)
    v_mfma_f32_32x32x16_bf16 v[192:207], v[72:75], v[136:139], v[192:207]
    s_waitcnt vmcnt(14)
    v_mfma_f32_32x32x16_bf16 v[192:207], v[76:79], v[140:143], v[192:207]
    s_waitcnt vmcnt(13)
    v_mfma_f32_32x32x16_bf16 v[192:207], v[80:83], v[144:147], v[192:207]
    s_waitcnt vmcnt(12)
    v_mfma_f32_32x32x16_bf16 v[192:207], v[84:87], v[148:151], v[192:207]
    s_waitcnt vmcnt(11)
    v_mfma_f32_32x32x16_bf16 v[192:207], v[88:91], v[152:155], v[192:207]
    s_waitcnt vmcnt(10)
    v_mfma_f32_32x32x16_bf16 v[192:207], v[92:95], v[156:159], v[192:207]
    s_waitcnt vmcnt(9)
    v_mfma_f32_32x32x16_bf16 v[192:207], v[96:99], v[160:163], v[192:207]
    s_waitcnt vmcnt(8)
    v_mfma_f32_32x32x16_bf16 v[192:207], v[100:103], v[164:167], v[192:207]
    s_waitcnt vmcnt(7)
    v_mfma_f32_32x32x16_bf16 v[192:207], v[104:107], v[168:171], v[192:207]
    s_waitcnt vmcnt(6)
    v_mfma_f32_32x32x16_bf16 v[192:207], v[108:111], v[172:175], v[192:207]
    s_waitcnt vmcnt(5)
    v_mfma_f32_32x32x16_bf16 v[192:207], v[112:115], v[176:179], v[192:207]
    s_waitcnt vmcnt(4)
    v_mfma_f32_32x32x16_bf16 v[192:207], v[116:119], v[180:183], v[192:207]
    s_waitcnt vmcnt(3)
    v_mfma_f32_32x32x16_bf16 v[192:207], v[120:123], v[184:187], v[192:207]
    s_waitcnt vmcnt(2)
    v_mfma_f32_32x32x16_bf16 v[192:207], v[124:127], v[188:191], v[192:207]
    s_nop 11
    v_cvt_pk_bf16_f32 v240, v192, v193
    v_cvt_pk_bf16_f32 v241, v194, v195
    v_cvt_pk_bf16_f32 v242, v196, v197
    v_cvt_pk_bf16_f32 v243, v198, v199
    v_cvt_pk_bf16_f32 v244, v200, v201
    v_cvt_pk_bf16_f32 v245, v202, v203
    v_cvt_pk_bf16_f32 v246, v204, v205
    v_cvt_pk_bf16_f32 v247, v206, v207
    s_add_u32 s26, s25, 16777216
    buffer_store_dwordx4 v[240:243], v1, s[12:15], s26 offen
    buffer_store_dwordx4 v[244:247], v1, s[12:15], s26 offen offset:1024
L_exit_k1_kernel:
    s_endpgm
.globl k2_kernel
.p2align 8
.type k2_kernel,@function
k2_kernel:
    s_cmp_ge_u32 s2, 256
    s_cbranch_scc1 L_exit_k2_kernel
    s_load_dwordx2 s[6:7], s[0:1], 96
    v_and_b32 v6, 63, v0
    v_lshrrev_b32 v7, 6, v0
    v_lshlrev_b32 v1, 4, v6
    v_readfirstlane_b32 s3, v7
    s_nop 0
    s_lshr_b32 s4, s3, 2
    s_and_b32 s5, s3, 3
    s_lshl_b32 s22, s4, 13
    v_add_u32 v2, s22, v1
    s_lshl_b32 s23, s5, 10
    s_add_u32 s19, s22, s23
    s_and_b32 s26, s2, 7
    s_lshr_b32 s25, s2, 3
    s_lshl_b32 s25, s25, 2
    s_add_u32 s25, s25, s5
    s_mul_i32 s22, s26, 512000
    s_add_u32 s18, s22, s23
    s_add_u32 s18, s18, 12582912
    s_min_u32 s24, s25, 124
    s_lshl_b32 s24, s24, 12
    s_add_u32 s24, s24, s22
    s_add_u32 s24, s24, 8388608
    s_mul_i32 s17, s4, 63
    s_sub_u32 s20, 63, s4
    s_mov_b32 s21, 0x3e38aa3b
    s_waitcnt lgkmcnt(0)
    s_mov_b32 s12, s6
    s_and_b32 s13, s7, 0xffff
    s_mov_b32 s14, 268435456
    s_mov_b32 s15, 0x00020000
    buffer_load_dwordx4 v[16:19], v1, s[12:15], s24 offen offset:0
    buffer_load_dwordx4 v[20:23], v1, s[12:15], s24 offen offset:1024
    buffer_load_dwordx4 v[24:27], v1, s[12:15], s24 offen offset:2048
    buffer_load_dwordx4 v[28:31], v1, s[12:15], s24 offen offset:3072
    s_mov_b32 s27, 0
    s_min_u32 s22, s17, 124
    s_lshl_b32 s22, s22, 12
    s_add_u32 s22, s22, s18
    s_add_u32 s23, s22, 4194304
    s_add_u32 s24, s19, s27
    s_mov_b32 m0, s24
    s_nop 0
    buffer_load_dwordx4 v1, s[12:15], s22 offen lds
    s_add_u32 m0, s24, 4096
    s_nop 0
    buffer_load_dwordx4 v1, s[12:15], s23 offen lds
    s_add_u32 s17, s17, 1
    s_add_u32 s27, s27, 16384
    s_and_b32 s27, s27, 0xffff
    s_min_u32 s22, s17, 124
    s_lshl_b32 s22, s22, 12
    s_add_u32 s22, s22, s18
    s_add_u32 s23, s22, 4194304
    s_add_u32 s24, s19, s27
    s_mov_b32 m0, s24
    s_nop 0
    buffer_load_dwordx4 v1, s[12:15], s22 offen lds
    s_add_u32 m0, s24, 4096
    s_nop 0
    buffer_load_dwordx4 v1, s[12:15], s23 offen lds
    s_add_u32 s17, s17, 1
    s_add_u32 s27, s27, 16384
    s_and_b32 s27, s27, 0xffff
    s_min_u32 s22, s17, 124
    s_lshl_b32 s22, s22, 12
    s_add_u32 s22, s22, s18
    s_add_u32 s23, s22, 4194304
    s_add_u32 s24, s19, s27
    s_mov_b32 m0, s24
    s_nop 0
    buffer_load_dwordx4 v1, s[12:15], s22 offen lds
    s_add_u32 m0, s24, 4096
    s_nop 0
    buffer_load_dwordx4 v1, s[12:15], s23 offen lds
    s_add_u32 s17, s17, 1
    s_add_u32 s27, s27, 16384
    s_and_b32 s27, s27, 0xffff
    v_mov_b32 v96, 0
    v_mov_b32 v97, 0
    v_mov_b32 v98, 0
    v_mov_b32 v99, 0
    v_mov_b32 v100, 0
    v_mov_b32 v101, 0
    v_mov_b32 v102, 0
    v_mov_b32 v103, 0
    v_mov_b32 v104, 0
    v_mov_b32 v105, 0
    v_mov_b32 v106, 0
    v_mov_b32 v107, 0
    v_mov_b32 v108, 0
    v_mov_b32 v109, 0
    v_mov_b32 v110, 0
    v_mov_b32 v111, 0
    v_mov_b32 v112, 0
    v_mov_b32 v113, 0
    v_mov_b32 v114, 0
    v_mov_b32 v115, 0
    v_mov_b32 v116, 0
    v_mov_b32 v117, 0
    v_mov_b32 v118, 0
    v_mov_b32 v119, 0
    v_mov_b32 v120, 0
    v_mov_b32 v121, 0
    v_mov_b32 v122, 0
    v_mov_b32 v123, 0
    v_mov_b32 v124, 0
    v_mov_b32 v125, 0
    v_mov_b32 v126, 0
    v_mov_b32 v127, 0
    v_mov_b32 v136, 0
    v_mov_b32 v138, 0xff800000
    v_mov_b32 v144, 0
    v_mov_b32 v145, 0
    v_mov_b32 v146, 0
    v_mov_b32 v147, 0
    v_mov_b32 v148, 0
    v_mov_b32 v149, 0
    v_mov_b32 v150, 0
    v_mov_b32 v151, 0
    v_mov_b32 v152, 0
    v_mov_b32 v153, 0
    v_mov_b32 v154, 0
    v_mov_b32 v155, 0
    v_mov_b32 v156, 0
    v_mov_b32 v157, 0
    v_mov_b32 v158, 0
    v_mov_b32 v159, 0
    v_mov_b32 v137, 0
    v_mov_b32 v139, 0x3e38aa3b
    v_mov_b32 v140, 0x40b17218
    s_waitcnt vmcnt(2)
    s_barrier
    ds_read_b128 v[32:35], v2 offset:0
    ds_read_b128 v[36:39], v2 offset:1024
    ds_read_b128 v[40:43], v2 offset:2048
    ds_read_b128 v[44:47], v2 offset:3072
    s_waitcnt lgkmcnt(3)
    v_mfma_f32_32x32x16_bf16 v[64:79], v[32:35], v[16:19], 0
    s_waitcnt lgkmcnt(2)
    v_mfma_f32_32x32x16_bf16 v[64:79], v[36:39], v[20:23], v[64:79]
    s_waitcnt lgkmcnt(1)
    v_mfma_f32_32x32x16_bf16 v[64:79], v[40:43], v[24:27], v[64:79]
    s_waitcnt lgkmcnt(0)
    v_mfma_f32_32x32x16_bf16 v[64:79], v[44:47], v[28:31], v[64:79]
    s_mov_b32 s28, 16384
    s_mov_b32 s29, 0
    s_nop 15
L_k2_loop:
    v_add_u32 v3, s28, v2
    v_add_u32 v4, s29, v2
    ds_read_b128 v[32:35], v3 offset:0
    ds_read_b128 v[36:39], v3 offset:1024
    ds_read_b128 v[40:43], v3 offset:2048
    ds_read_b128 v[44:47], v3 offset:3072
    v_max3_f32 v6, v64, v65, v66
    s_min_u32 s22, s17, 124
    v_max3_f32 v7, v67, v68, v69
    s_lshl_b32 s22, s22, 12
    v_max3_f32 v8, v70, v71, v72
    s_add_u32 s22, s22, s18
    v_max3_f32 v9, v73, v74, v75
    s_add_u32 s23, s22, 4194304
    v_max3_f32 v10, v76, v77, v78
    s_add_u32 s24, s19, s27
    v_max3_f32 v6, v6, v7, v79
    s_mov_b32 m0, s24
    v_max3_f32 v8, v8, v9, v10
    buffer_load_dwordx4 v1, s[12:15], s22 offen lds
    s_add_u32 m0, s24, 4096
    v_max_f32 v6, v6, v8
    buffer_load_dwordx4 v1, s[12:15], s23 offen lds
    v_cmp_gt_f32 vcc, v6, v138
    ds_read_b128 v[48:51], v4 offset:4096
    ds_read_b128 v[52:55], v4 offset:5120
    ds_read_b128 v[56:59], v4 offset:6144
    ds_read_b128 v[60:63], v4 offset:7168
    s_mov_b32 s30, 0
    s_cbranch_vccnz L_k2_rescale
L_k2_back0:
    s_waitcnt lgkmcnt(7)
    v_mfma_f32_32x32x16_bf16 v[80:95], v[32:35], v[16:19], v[144:159]
    s_add_u32 s17, s17, 1
    s_add_u32 s27, s27, 16384
    s_and_b32 s27, s27, 0xffff
    s_mov_b32 s29, s28
    s_add_u32 s28, s28, 16384
    s_and_b32 s28, s28, 0xffff
    s_waitcnt lgkmcnt(6)
    v_mfma_f32_32x32x16_bf16 v[80:95], v[36:39], v[20:23], v[80:95]
    v_exp_f32 v64, v64
    v_exp_f32 v65, v65
    v_exp_f32 v66, v66
    v_exp_f32 v67, v67
    v_exp_f32 v68, v68
    v_exp_f32 v69, v69
    v_exp_f32 v70, v70
    v_exp_f32 v71, v71
    s_waitcnt lgkmcnt(5)
    v_mfma_f32_32x32x16_bf16 v[80:95], v[40:43], v[24:27], v[80:95]
    v_add_f32 v7, v64, v65
    v_add_f32 v8, v66, v67
    v_cvt_pk_bf16_f32 v128, v64, v65
    v_cvt_pk_bf16_f32 v129, v66, v67
    v_cvt_pk_bf16_f32 v130, v68, v69
    v_cvt_pk_bf16_f32 v131, v70, v71
    v_add_f32 v7, v7, v68
    v_add_f32 v8, v8, v69
    v_add_f32 v7, v7, v70
    v_add_f32 v8, v8, v71
    s_waitcnt lgkmcnt(4)
    v_mfma_f32_32x32x16_bf16 v[80:95], v[44:47], v[28:31], v[80:95]
    s_cmp_lg_u32 s4, 1
    s_cbranch_scc1 L_k2_sy1_0
    s_waitcnt vmcnt(2) lgkmcnt(0)
    s_barrier
L_k2_sy1_0:
    s_waitcnt lgkmcnt(3)
    v_mfma_f32_32x32x16_bf16 v[96:111], v[48:51], v[128:131], v[96:111]
    v_exp_f32 v72, v72
    v_exp_f32 v73, v73
    v_exp_f32 v74, v74
    v_exp_f32 v75, v75
    v_exp_f32 v76, v76
    v_exp_f32 v77, v77
    v_exp_f32 v78, v78
    v_exp_f32 v79, v79
    s_waitcnt lgkmcnt(1)
    v_mfma_f32_32x32x16_bf16 v[112:127], v[56:59], v[128:131], v[112:127]
    v_cvt_pk_bf16_f32 v132, v72, v73
    v_cvt_pk_bf16_f32 v133, v74, v75
    v_cvt_pk_bf16_f32 v134, v76, v77
    v_cvt_pk_bf16_f32 v135, v78, v79
    v_add_f32 v7, v7, v72
    v_add_f32 v8, v8, v73
    v_add_f32 v7, v7, v74
    v_add_f32 v8, v8, v75
    v_add_f32 v7, v7, v76
    v_add_f32 v8, v8, v77
    v_add_f32 v7, v7, v78
    v_add_f32 v8, v8, v79
    v_mfma_f32_32x32x16_bf16 v[96:111], v[52:55], v[132:135], v[96:111]
    v_add_f32 v7, v7, v8
    v_add_f32 v137, v137, v7
    s_waitcnt lgkmcnt(0)
    v_mfma_f32_32x32x16_bf16 v[112:127], v[60:63], v[132:135], v[112:127]
    s_sub_u32 s20, s20, 1
    s_cmp_lg_u32 s4, 0
    s_cbranch_scc1 L_k2_sy0_0
    s_waitcnt vmcnt(2) lgkmcnt(0)
    s_barrier
L_k2_sy0_0:
    s_cmp_eq_u32 s20, 0
    s_cbranch_scc1 L_k2_done
    v_add_u32 v3, s28, v2
    v_add_u32 v4, s29, v2
    ds_read_b128 v[32:35], v3 offset:0
    ds_read_b128 v[36:39], v3 offset:1024
    ds_read_b128 v[40:43], v3 offset:2048
    ds_read_b128 v[44:47], v3 offset:3072
    v_max3_f32 v6, v80, v81, v82
    s_min_u32 s22, s17, 124
    v_max3_f32 v7, v83, v84, v85
    s_lshl_b32 s22, s22, 12
    v_max3_f32 v8, v86, v87, v88
    s_add_u32 s22, s22, s18
    v_max3_f32 v9, v89, v90, v91
    s_add_u32 s23, s22, 4194304
    v_max3_f32 v10, v92, v93, v94
    s_add_u32 s24, s19, s27
    v_max3_f32 v6, v6, v7, v95
    s_mov_b32 m0, s24
    v_max3_f32 v8, v8, v9, v10
    buffer_load_dwordx4 v1, s[12:15], s22 offen lds
    s_add_u32 m0, s24, 4096
    v_max_f32 v6, v6, v8
    buffer_load_dwordx4 v1, s[12:15], s23 offen lds
    v_cmp_gt_f32 vcc, v6, v138
    ds_read_b128 v[48:51], v4 offset:4096
    ds_read_b128 v[52:55], v4 offset:5120
    ds_read_b128 v[56:59], v4 offset:6144
    ds_read_b128 v[60:63], v4 offset:7168
    s_mov_b32 s30, 1
    s_cbranch_vccnz L_k2_rescale
L_k2_back1:
    s_waitcnt lgkmcnt(7)
    v_mfma_f32_32x32x16_bf16 v[64:79], v[32:35], v[16:19], v[144:159]
    s_add_u32 s17, s17, 1
    s_add_u32 s27, s27, 16384
    s_and_b32 s27, s27, 0xffff
    s_mov_b32 s29, s28
    s_add_u32 s28, s28, 16384
    s_and_b32 s28, s28, 0xffff
    s_waitcnt lgkmcnt(6)
    v_mfma_f32_32x32x16_bf16 v[64:79], v[36:39], v[20:23], v[64:79]
    v_exp_f32 v80, v80
    v_exp_f32 v81, v81
    v_exp_f32 v82, v82
    v_exp_f32 v83, v83
    v_exp_f32 v84, v84
    v_exp_f32 v85, v85
    v_exp_f32 v86, v86
    v_exp_f32 v87, v87
    s_waitcnt lgkmcnt(5)
    v_mfma_f32_32x32x16_bf16 v[64:79], v[40:43], v[24:27], v[64:79]
    v_add_f32 v7, v80, v81
    v_add_f32 v8, v82, v83
    v_cvt_pk_bf16_f32 v128, v80, v81
    v_cvt_pk_bf16_f32 v129, v82, v83
    v_cvt_pk_bf16_f32 v130, v84, v85
    v_cvt_pk_bf16_f32 v131, v86, v87
    v_add_f32 v7, v7, v84
    v_add_f32 v8, v8, v85
    v_add_f32 v7, v7, v86
    v_add_f32 v8, v8, v87
    s_waitcnt lgkmcnt(4)
    v_mfma_f32_32x32x16_bf16 v[64:79], v[44:47], v[28:31], v[64:79]
    s_cmp_lg_u32 s4, 1
    s_cbranch_scc1 L_k2_sy1_1
    s_waitcnt vmcnt(2) lgkmcnt(0)
    s_barrier
L_k2_sy1_1:
    s_waitcnt lgkmcnt(3)
    v_mfma_f32_32x32x16_bf16 v[96:111], v[48:51], v[128:131], v[96:111]
    v_exp_f32 v88, v88
    v_exp_f32 v89, v89
    v_exp_f32 v90, v90
    v_exp_f32 v91, v91
    v_exp_f32 v92, v92
    v_exp_f32 v93, v93
    v_exp_f32 v94, v94
    v_exp_f32 v95, v95
    s_waitcnt lgkmcnt(1)
    v_mfma_f32_32x32x16_bf16 v[112:127], v[56:59], v[128:131], v[112:127]
    v_cvt_pk_bf16_f32 v132, v88, v89
    v_cvt_pk_bf16_f32 v133, v90, v91
    v_cvt_pk_bf16_f32 v134, v92, v93
    v_cvt_pk_bf16_f32 v135, v94, v95
    v_add_f32 v7, v7, v88
    v_add_f32 v8, v8, v89
    v_add_f32 v7, v7, v90
    v_add_f32 v8, v8, v91
    v_add_f32 v7, v7, v92
    v_add_f32 v8, v8, v93
    v_add_f32 v7, v7, v94
    v_add_f32 v8, v8, v95
    v_mfma_f32_32x32x16_bf16 v[96:111], v[52:55], v[132:135], v[96:111]
    v_add_f32 v7, v7, v8
    v_add_f32 v137, v137, v7
    s_waitcnt lgkmcnt(0)
    v_mfma_f32_32x32x16_bf16 v[112:127], v[60:63], v[132:135], v[112:127]
    s_sub_u32 s20, s20, 1
    s_cmp_lg_u32 s4, 0
    s_cbranch_scc1 L_k2_sy0_1
    s_waitcnt vmcnt(2) lgkmcnt(0)
    s_barrier
L_k2_sy0_1:
    s_cmp_lg_u32 s20, 0
    s_cbranch_scc1 L_k2_loop
L_k2_done:
    s_cmp_eq_u32 s4, 0
    s_cbranch_scc1 L_k2_nobar
    s_barrier
L_k2_nobar:
    s_waitcnt vmcnt(0)
    s_nop 15
    s_barrier
    s_mul_i32 s22, s5, 9216
    v_add_u32 v6, s22, v1
    v_lshrrev_b32 v7, 1, v1
    v_add_u32 v7, s22, v7
    s_cmp_eq_u32 s4, 0
    s_cbranch_scc1 L_k2_lo
    ds_write_b128 v6, v[96:99] offset:0
    ds_write_b128 v6, v[100:103] offset:1024
    ds_write_b128 v6, v[104:107] offset:2048
    ds_write_b128 v6, v[108:111] offset:3072
    ds_write_b128 v6, v[112:115] offset:4096
    ds_write_b128 v6, v[116:119] offset:5120
    ds_write_b128 v6, v[120:123] offset:6144
    ds_write_b128 v6, v[124:127] offset:7168
    ds_write_b64 v7, v[136:137] offset:8192
    s_waitcnt lgkmcnt(0)
    s_barrier
    s_branch L_exit_k2_kernel
L_k2_lo:
    s_barrier
    ds_read_b128 v[160:163], v6 offset:0
    ds_read_b128 v[164:167], v6 offset:1024
    ds_read_b128 v[168:171], v6 offset:2048
    ds_read_b128 v[172:175], v6 offset:3072
    ds_read_b128 v[176:179], v6 offset:4096
    ds_read_b128 v[180:183], v6 offset:5120
    ds_read_b128 v[184:187], v6 offset:6144
    ds_read_b128 v[188:191], v6 offset:7168
    ds_read_b64 v[192:193], v7 offset:8192
    s_waitcnt lgkmcnt(0)
    v_max_f32 v8, v136, v192
    v_sub_f32 v9, v136, v8
    v_sub_f32 v10, v192, v8
    v_exp_f32 v9, v9
    v_exp_f32 v10, v10
    v_mul_f32 v137, v137, v9
    v_fma_f32 v137, v193, v10, v137
    v_mov_b32 v11, v137
    s_nop 1
    v_permlane32_swap_b32 v137, v11
    v_add_f32 v137, v137, v11
    v_rcp_f32 v137, v137
    s_nop 0
    v_mul_f32 v9, v9, v137
    v_mul_f32 v10, v10, v137
    v_mul_f32 v96, v96, v9
    v_mul_f32 v97, v97, v9
    v_mul_f32 v98, v98, v9
    v_mul_f32 v99, v99, v9
    v_mul_f32 v100, v100, v9
    v_mul_f32 v101, v101, v9
    v_mul_f32 v102, v102, v9
    v_mul_f32 v103, v103, v9
    v_mul_f32 v104, v104, v9
    v_mul_f32 v105, v105, v9
    v_mul_f32 v106, v106, v9
    v_mul_f32 v107, v107, v9
    v_mul_f32 v108, v108, v9
    v_mul_f32 v109, v109, v9
    v_mul_f32 v110, v110, v9
    v_mul_f32 v111, v111, v9
    v_mul_f32 v112, v112, v9
    v_mul_f32 v113, v113, v9
    v_mul_f32 v114, v114, v9
    v_mul_f32 v115, v115, v9
    v_mul_f32 v116, v116, v9
    v_mul_f32 v117, v117, v9
    v_mul_f32 v118, v118, v9
    v_mul_f32 v119, v119, v9
    v_mul_f32 v120, v120, v9
    v_mul_f32 v121, v121, v9
    v_mul_f32 v122, v122, v9
    v_mul_f32 v123, v123, v9
    v_mul_f32 v124, v124, v9
    v_mul_f32 v125, v125, v9
    v_mul_f32 v126, v126, v9
    v_mul_f32 v127, v127, v9
    v_fma_f32 v96, v160, v10, v96
    v_fma_f32 v97, v161, v10, v97
    v_fma_f32 v98, v162, v10, v98
    v_fma_f32 v99, v163, v10, v99
    v_fma_f32 v100, v164, v10, v100
    v_fma_f32 v101, v165, v10, v101
    v_fma_f32 v102, v166, v10, v102
    v_fma_f32 v103, v167, v10, v103
    v_fma_f32 v104, v168, v10, v104
    v_fma_f32 v105, v169, v10, v105
    v_fma_f32 v106, v170, v10, v106
    v_fma_f32 v107, v171, v10, v107
    v_fma_f32 v108, v172, v10, v108
    v_fma_f32 v109, v173, v10, v109
    v_fma_f32 v110, v174, v10, v110
    v_fma_f32 v111, v175, v10, v111
    v_fma_f32 v112, v176, v10, v112
    v_fma_f32 v113, v177, v10, v113
    v_fma_f32 v114, v178, v10, v114
    v_fma_f32 v115, v179, v10, v115
    v_fma_f32 v116, v180, v10, v116
    v_fma_f32 v117, v181, v10, v117
    v_fma_f32 v118, v182, v10, v118
    v_fma_f32 v119, v183, v10, v119
    v_fma_f32 v120, v184, v10, v120
    v_fma_f32 v121, v185, v10, v121
    v_fma_f32 v122, v186, v10, v122
    v_fma_f32 v123, v187, v10, v123
    v_fma_f32 v124, v188, v10, v124
    v_fma_f32 v125, v189, v10, v125
    v_fma_f32 v126, v190, v10, v126
    v_fma_f32 v127, v191, v10, v127
    v_cvt_pk_bf16_f32 v160, v96, v97
    v_cvt_pk_bf16_f32 v161, v98, v99
    v_cvt_pk_bf16_f32 v162, v100, v101
    v_cvt_pk_bf16_f32 v163, v102, v103
    v_cvt_pk_bf16_f32 v164, v104, v105
    v_cvt_pk_bf16_f32 v165, v106, v107
    v_cvt_pk_bf16_f32 v166, v108, v109
    v_cvt_pk_bf16_f32 v167, v110, v111
    v_cvt_pk_bf16_f32 v168, v112, v113
    v_cvt_pk_bf16_f32 v169, v114, v115
    v_cvt_pk_bf16_f32 v170, v116, v117
    v_cvt_pk_bf16_f32 v171, v118, v119
    v_cvt_pk_bf16_f32 v172, v120, v121
    v_cvt_pk_bf16_f32 v173, v122, v123
    v_cvt_pk_bf16_f32 v174, v124, v125
    v_cvt_pk_bf16_f32 v175, v126, v127
    s_cmp_ge_u32 s25, 125
    s_cbranch_scc1 L_exit_k2_kernel
    s_lshr_b32 s22, s26, 2
    s_mul_i32 s22, s22, 125
    s_add_u32 s22, s22, s25
    s_lshl_b32 s22, s22, 14
    s_and_b32 s23, s26, 3
    s_lshl_b32 s23, s23, 12
    s_add_u32 s22, s22, s23
    s_add_u32 s22, s22, 20971520
    buffer_store_dwordx4 v[160:163], v1, s[12:15], s22 offen offset:0
    buffer_store_dwordx4 v[164:167], v1, s[12:15], s22 offen offset:1024
    buffer_store_dwordx4 v[168:171], v1, s[12:15], s22 offen offset:2048
    buffer_store_dwordx4 v[172:175], v1, s[12:15], s22 offen offset:3072
    s_branch L_exit_k2_kernel
L_k2_rescale:
    s_nop 15
    s_nop 7
    v_mov_b32 v7, v6
    s_nop 1
    v_permlane32_swap_b32 v6, v7
    v_max_f32 v6, v6, v7
    v_max_f32 v7, 0, v6
    v_cmp_gt_f32 vcc, 0, v138
    s_nop 1
    v_cndmask_b32 v6, v7, v6, vcc
    v_sub_f32 v7, 0, v7
    v_exp_f32 v7, v7
    v_add_f32 v136, v136, v6
    v_mov_b32 v138, 0x41000000
    v_mul_f32 v137, v137, v7
    v_mul_f32 v96, v96, v7
    v_mul_f32 v97, v97, v7
    v_mul_f32 v98, v98, v7
    v_mul_f32 v99, v99, v7
    v_mul_f32 v100, v100, v7
    v_mul_f32 v101, v101, v7
    v_mul_f32 v102, v102, v7
    v_mul_f32 v103, v103, v7
    v_mul_f32 v104, v104, v7
    v_mul_f32 v105, v105, v7
    v_mul_f32 v106, v106, v7
    v_mul_f32 v107, v107, v7
    v_mul_f32 v108, v108, v7
    v_mul_f32 v109, v109, v7
    v_mul_f32 v110, v110, v7
    v_mul_f32 v111, v111, v7
    v_mul_f32 v112, v112, v7
    v_mul_f32 v113, v113, v7
    v_mul_f32 v114, v114, v7
    v_mul_f32 v115, v115, v7
    v_mul_f32 v116, v116, v7
    v_mul_f32 v117, v117, v7
    v_mul_f32 v118, v118, v7
    v_mul_f32 v119, v119, v7
    v_mul_f32 v120, v120, v7
    v_mul_f32 v121, v121, v7
    v_mul_f32 v122, v122, v7
    v_mul_f32 v123, v123, v7
    v_mul_f32 v124, v124, v7
    v_mul_f32 v125, v125, v7
    v_mul_f32 v126, v126, v7
    v_mul_f32 v127, v127, v7
    v_sub_f32 v8, 0, v136
    v_mov_b32 v144, v8
    v_mov_b32 v145, v8
    v_mov_b32 v146, v8
    v_mov_b32 v147, v8
    v_mov_b32 v148, v8
    v_mov_b32 v149, v8
    v_mov_b32 v150, v8
    v_mov_b32 v151, v8
    v_mov_b32 v152, v8
    v_mov_b32 v153, v8
    v_mov_b32 v154, v8
    v_mov_b32 v155, v8
    v_mov_b32 v156, v8
    v_mov_b32 v157, v8
    v_mov_b32 v158, v8
    v_mov_b32 v159, v8
    s_cmp_eq_u32 s30, 0
    s_cbranch_scc0 L_k2_rs1
    v_sub_f32 v64, v64, v6
    v_sub_f32 v65, v65, v6
    v_sub_f32 v66, v66, v6
    v_sub_f32 v67, v67, v6
    v_sub_f32 v68, v68, v6
    v_sub_f32 v69, v69, v6
    v_sub_f32 v70, v70, v6
    v_sub_f32 v71, v71, v6
    v_sub_f32 v72, v72, v6
    v_sub_f32 v73, v73, v6
    v_sub_f32 v74, v74, v6
    v_sub_f32 v75, v75, v6
    v_sub_f32 v76, v76, v6
    v_sub_f32 v77, v77, v6
    v_sub_f32 v78, v78, v6
    v_sub_f32 v79, v79, v6
    s_branch L_k2_rs2
L_k2_rs1:
    v_sub_f32 v80, v80, v6
    v_sub_f32 v81, v81, v6
    v_sub_f32 v82, v82, v6
    v_sub_f32 v83, v83, v6
    v_sub_f32 v84, v84, v6
    v_sub_f32 v85, v85, v6
    v_sub_f32 v86, v86, v6
    v_sub_f32 v87, v87, v6
    v_sub_f32 v88, v88, v6
    v_sub_f32 v89, v89, v6
    v_sub_f32 v90, v90, v6
    v_sub_f32 v91, v91, v6
    v_sub_f32 v92, v92, v6
    v_sub_f32 v93, v93, v6
    v_sub_f32 v94, v94, v6
    v_sub_f32 v95, v95, v6
L_k2_rs2:
    s_nop 3
    s_cmp_eq_u32 s30, 0
    s_cbranch_scc1 L_k2_back0
    s_branch L_k2_back1
L_exit_k2_kernel:
    s_endpgm
.globl k3_kernel
.p2align 8
.type k3_kernel,@function
k3_kernel:
    s_cmp_ge_u32 s2, 250
    s_cbranch_scc1 L_exit_k3_kernel
    s_load_dwordx2 s[4:5], s[0:1], 0
    s_load_dwordx2 s[6:7], s[0:1], 96
    s_load_dwordx2 s[34:35], s[0:1], 80
    s_load_dwordx2 s[36:37], s[0:1], 48
    v_and_b32 v8, 63, v0
    v_lshrrev_b32 v9, 6, v0
    v_lshlrev_b32 v1, 4, v8
    v_readfirstlane_b32 s3, v9
    v_and_b32 v10, 31, v8
    v_lshrrev_b32 v11, 5, v8
    v_add_u32 v2, 65536, v1
    v_lshlrev_b32 v12, 11, v9
    v_add_u32 v3, v2, v12
    v_lshlrev_b32 v12, 13, v9
    v_add_u32 v4, v1, v12
    v_mul_u32_u24 v6, 144, v10
    v_add_u32 v6, 81920, v6
    v_lshlrev_b32 v12, 4, v9
    v_lshlrev_b32 v13, 3, v11
    v_add3_u32 v5, v6, v12, v13
    v_lshlrev_b32 v7, 9, v10
    v_add_u32 v7, v7, v13
    s_mov_b32 s29, s2
    s_cmp_ge_u32 s2, 125
    s_cselect_b32 s30, 1, 0
    s_mul_i32 s25, s30, 125
    s_sub_u32 s31, s2, s25
    s_waitcnt lgkmcnt(0)
    s_mov_b32 s8, s4
    s_and_b32 s9, s5, 0xffff
    s_mov_b32 s10, 4096000
    s_mov_b32 s11, 0x00020000
    s_mov_b32 s12, s6
    s_and_b32 s13, s7, 0xffff
    s_mov_b32 s14, 268435456
    s_mov_b32 s15, 0x00020000
    s_mov_b32 s16, s34
    s_and_b32 s17, s35, 0xffff
    s_mov_b32 s18, 4096000
    s_mov_b32 s19, 0x00020000
    s_mov_b32 s20, s36
    s_and_b32 s21, s37, 0xffff
    s_mov_b32 s22, 2560
    s_mov_b32 s23, 0x00020000
    s_mul_i32 s24, s3, 49152
    s_add_u32 s24, s24, 1441792
    v_and_b32 v8, 31, v0
    v_lshrrev_b32 v9, 5, v0
    v_and_b32 v9, 1, v9
    s_lshl_b32 s25, s31, 5
    v_add_u32 v10, -2, v8
    v_add_u32 v11, 30, v8
    v_cmp_gt_u32 vcc, 2, v8
    s_nop 1
    v_cndmask_b32 v10, v11, v10, vcc
    v_cmp_gt_u32 vcc, 4, v8
    s_nop 1
    v_cndmask_b32 v10, 0, v10, vcc
    v_add_u32 v10, s25, v10
    s_movk_i32 s26, 4000
    v_cmp_gt_u32 vcc, s26, v10
    s_nop 1
    v_cndmask_b32 v57, 0, 1.0, vcc
    v_cndmask_b32 v10, 0, v10, vcc
    v_lshrrev_b32 v11, 5, v10
    v_lshlrev_b32 v11, 14, v11
    v_and_b32 v12, 31, v10
    v_lshlrev_b32 v12, 4, v12
    v_lshlrev_b32 v13, 9, v9
    v_add3_u32 v56, v11, v12, v13
    s_mul_i32 s26, s3, 5440
    s_add_u32 s26, s26, 21504
    v_mul_u32_u24 v11, 80, v8
    v_lshlrev_b32 v12, 5, v9
    v_add3_u32 v59, v11, v12, s26
    v_add_u32 v13, 32, v8
    v_cmp_gt_u32 vcc, 2, v8
    s_nop 1
    v_cndmask_b32 v13, v13, v8, vcc
    v_add_u32 v14, 36, v8
    v_cmp_gt_u32 vcc, 4, v8
    s_nop 1
    v_cndmask_b32 v13, v14, v13, vcc
    v_mul_u32_u24 v13, 80, v13
    v_add3_u32 v58, v13, v12, s26
    v_add_u32 v60, -65536, v5
    v_add_u32 v61, -65536, v3
    s_mov_b32 m0, 86528
    s_mov_b32 s25, 0
    buffer_load_dwordx4 v1, s[20:23], s25 offen lds
    s_mov_b32 m0, 87552
    s_mov_b32 s25, 1024
    buffer_load_dwordx4 v1, s[20:23], s25 offen lds
    s_mov_b32 m0, 88576
    s_mov_b32 s25, 2048
    buffer_load_dwordx4 v1, s[20:23], s25 offen lds
    s_lshl_b32 s25, s29, 14
    s_lshl_b32 s28, s3, 11
    s_add_u32 s25, s25, s28
    s_add_u32 s25, s25, 20971520
    buffer_load_dwordx4 v[240:243], v1, s[12:15], s25 offen
    buffer_load_dwordx4 v[244:247], v1, s[12:15], s25 offen offset:1024
    s_mul_i32 s26, s30, 2048000
    s_lshl_b32 s27, s3, 11
    s_add_u32 s26, s26, s27
    s_add_u32 s27, s26, 20971520
    buffer_load_dwordx4 v[248:251], v56, s[12:15], s27 offen
    buffer_load_dwordx4 v[252:255], v56, s[12:15], s27 offen offset:1024
    s_lshl_b32 s25, s29, 14
    s_lshl_b32 s28, s3, 11
    s_add_u32 s25, s25, s28
    s_add_u32 s25, s25, 4194304
    buffer_load_dwordx4 v[192:195], v1, s[12:15], s25 offen
    buffer_load_dwordx4 v[196:199], v1, s[12:15], s25 offen offset:1024
    s_add_u32 s27, s26, 4194304
    buffer_load_dwordx4 v[200:203], v56, s[12:15], s27 offen
    buffer_load_dwordx4 v[204:207], v56, s[12:15], s27 offen offset:1024
    buffer_load_dwordx4 v[128:131], v1, s[12:15], s24 offen offset:0
    buffer_load_dwordx4 v[132:135], v1, s[12:15], s24 offen offset:1024
    buffer_load_dwordx4 v[136:139], v1, s[12:15], s24 offen offset:2048
    buffer_load_dwordx4 v[140:143], v1, s[12:15], s24 offen offset:3072
    s_add_u32 s24, s24, 4096
    buffer_load_dwordx4 v[144:147], v1, s[12:15], s24 offen offset:0
    buffer_load_dwordx4 v[148:151], v1, s[12:15], s24 offen offset:1024
    buffer_load_dwordx4 v[152:155], v1, s[12:15], s24 offen offset:2048
    buffer_load_dwordx4 v[156:159], v1, s[12:15], s24 offen offset:3072
    s_add_u32 s24, s24, 4096
    buffer_load_dwordx4 v[160:163], v1, s[12:15], s24 offen offset:0
    buffer_load_dwordx4 v[164:167], v1, s[12:15], s24 offen offset:1024
    buffer_load_dwordx4 v[168:171], v1, s[12:15], s24 offen offset:2048
    buffer_load_dwordx4 v[172:175], v1, s[12:15], s24 offen offset:3072
    s_add_u32 s24, s24, 4096
    buffer_load_dwordx4 v[176:179], v1, s[12:15], s24 offen offset:0
    buffer_load_dwordx4 v[180:183], v1, s[12:15], s24 offen offset:1024
    buffer_load_dwordx4 v[184:187], v1, s[12:15], s24 offen offset:2048
    buffer_load_dwordx4 v[188:191], v1, s[12:15], s24 offen offset:3072
    s_add_u32 s24, s24, 4096
    s_waitcnt vmcnt(23)
    ds_write_b128 v3, v[240:243]
    s_waitcnt vmcnt(22)
    ds_write_b128 v3, v[244:247] offset:1024
    s_waitcnt vmcnt(21)
    ds_write_b128 v61, v[248:251]
    s_waitcnt vmcnt(20)
    ds_write_b128 v61, v[252:255] offset:1024
    s_waitcnt lgkmcnt(0)
    s_barrier
    ds_read_b128 v[64:67], v2 offset:0
    ds_read_b128 v[68:71], v2 offset:1024
    ds_read_b128 v[72:75], v2 offset:2048
    ds_read_b128 v[76:79], v2 offset:3072
    ds_read_b128 v[80:83], v2 offset:4096
    ds_read_b128 v[84:87], v2 offset:5120
    ds_read_b128 v[88:91], v2 offset:6144
    ds_read_b128 v[92:95], v2 offset:7168
    ds_read_b128 v[96:99], v2 offset:8192
    ds_read_b128 v[100:103], v2 offset:9216
    ds_read_b128 v[104:107], v2 offset:10240
    ds_read_b128 v[108:111], v2 offset:11264
    ds_read_b128 v[112:115], v2 offset:12288
    ds_read_b128 v[116:119], v2 offset:13312
    ds_read_b128 v[120:123], v2 offset:14336
    ds_read_b128 v[124:127], v2 offset:15360
    s_waitcnt vmcnt(19)
    v_lshlrev_b32 v224, 16, v192
    v_and_b32 v225, 0xffff0000, v192
    v_lshlrev_b32 v226, 16, v193
    v_and_b32 v227, 0xffff0000, v193
    v_lshlrev_b32 v228, 16, v194
    v_and_b32 v229, 0xffff0000, v194
    v_lshlrev_b32 v230, 16, v195
    v_and_b32 v231, 0xffff0000, v195
    s_waitcnt vmcnt(18)
    v_lshlrev_b32 v232, 16, v196
    v_and_b32 v233, 0xffff0000, v196
    v_lshlrev_b32 v234, 16, v197
    v_and_b32 v235, 0xffff0000, v197
    v_lshlrev_b32 v236, 16, v198
    v_and_b32 v237, 0xffff0000, v198
    v_lshlrev_b32 v238, 16, v199
    v_and_b32 v239, 0xffff0000, v199
    s_waitcnt vmcnt(17)
    v_lshlrev_b32 v26, 16, v200
    v_and_b32 v27, 0xffff0000, v200
    v_lshlrev_b32 v28, 16, v201
    v_and_b32 v29, 0xffff0000, v201
    v_lshlrev_b32 v30, 16, v202
    v_and_b32 v31, 0xffff0000, v202
    v_lshlrev_b32 v32, 16, v203
    v_and_b32 v33, 0xffff0000, v203
    s_waitcnt vmcnt(16)
    v_lshlrev_b32 v34, 16, v204
    v_and_b32 v35, 0xffff0000, v204
    v_lshlrev_b32 v36, 16, v205
    v_and_b32 v37, 0xffff0000, v205
    v_lshlrev_b32 v38, 16, v206
    v_and_b32 v39, 0xffff0000, v206
    v_lshlrev_b32 v40, 16, v207
    v_and_b32 v41, 0xffff0000, v207
    ds_read_b128 v[44:47], v1 offset:0
    ds_read_b128 v[48:51], v1 offset:1024
    ds_read_b128 v[52:55], v1 offset:2048
    s_waitcnt vmcnt(15) lgkmcnt(15)
    v_mfma_f32_32x32x16_bf16 v[192:207], v[128:131], v[64:67], 0
    s_waitcnt lgkmcnt(2)
    v_mfma_f32_32x32x16_bf16 v[8:23], v[128:131], v[44:47], 0
    buffer_load_dwordx4 v[128:131], v1, s[12:15], s24 offen offset:0
    ds_read_b128 v[44:47], v1 offset:3072
    s_waitcnt vmcnt(15)
    v_mfma_f32_32x32x16_bf16 v[192:207], v[132:135], v[68:71], v[192:207]
    s_waitcnt lgkmcnt(2)
    v_mfma_f32_32x32x16_bf16 v[8:23], v[132:135], v[48:51], v[8:23]
    buffer_load_dwordx4 v[132:135], v1, s[12:15], s24 offen offset:1024
    ds_read_b128 v[48:51], v1 offset:4096
    s_waitcnt vmcnt(15)
    v_mfma_f32_32x32x16_bf16 v[192:207], v[136:139], v[72:75], v[192:207]
    s_waitcnt lgkmcnt(2)
    v_mfma_f32_32x32x16_bf16 v[8:23], v[136:139], v[52:55], v[8:23]
    buffer_load_dwordx4 v[136:139], v1, s[12:15], s24 offen offset:2048
    ds_read_b128 v[52:55], v1 offset:5120
    s_waitcnt vmcnt(15)
    v_mfma_f32_32x32x16_bf16 v[192:207], v[140:143], v[76:79], v[192:207]
    s_waitcnt lgkmcnt(2)
    v_mfma_f32_32x32x16_bf16 v[8:23], v[140:143], v[44:47], v[8:23]
    buffer_load_dwordx4 v[140:143], v1, s[12:15], s24 offen offset:3072
    s_add_u32 s24, s24, 4096
    ds_read_b128 v[44:47], v1 offset:6144
    s_waitcnt vmcnt(15)
    v_mfma_f32_32x32x16_bf16 v[192:207], v[144:147], v[80:83], v[192:207]
    s_waitcnt lgkmcnt(2)
    v_mfma_f32_32x32x16_bf16 v[8:23], v[144:147], v[48:51], v[8:23]
    buffer_load_dwordx4 v[144:147], v1, s[12:15], s24 offen offset:0
    ds_read_b128 v[48:51], v1 offset:7168
    s_waitcnt vmcnt(15)
    v_mfma_f32_32x32x16_bf16 v[192:207], v[148:151], v[84:87], v[192:207]
    s_waitcnt lgkmcnt(2)
    v_mfma_f32_32x32x16_bf16 v[8:23], v[148:151], v[52:55], v[8:23]
    buffer_load_dwordx4 v[148:151], v1, s[12:15], s24 offen offset:1024
    ds_read_b128 v[52:55], v1 offset:8192
    s_waitcnt vmcnt(15)
    v_mfma_f32_32x32x16_bf16 v[192:207], v[152:155], v[88:91], v[192:207]
    s_waitcnt lgkmcnt(2)
    v_mfma_f32_32x32x16_bf16 v[8:23], v[152:155], v[44:47], v[8:23]
    buffer_load_dwordx4 v[152:155], v1, s[12:15], s24 offen offset:2048
    ds_read_b128 v[44:47], v1 offset:9216
    s_waitcnt vmcnt(15)
    v_mfma_f32_32x32x16_bf16 v[192:207], v[156:159], v[92:95], v[192:207]
    s_waitcnt lgkmcnt(2)
    v_mfma_f32_32x32x16_bf16 v[8:23], v[156:159], v[48:51], v[8:23]
    buffer_load_dwordx4 v[156:159], v1, s[12:15], s24 offen offset:3072
    s_add_u32 s24, s24, 4096
    ds_read_b128 v[48:51], v1 offset:10240
    s_waitcnt vmcnt(15)
    v_mfma_f32_32x32x16_bf16 v[192:207], v[160:163], v[96:99], v[192:207]
    s_waitcnt lgkmcnt(2)
    v_mfma_f32_32x32x16_bf16 v[8:23], v[160:163], v[52:55], v[8:23]
    buffer_load_dwordx4 v[160:163], v1, s[12:15], s24 offen offset:0
    ds_read_b128 v[52:55], v1 offset:11264
    s_waitcnt vmcnt(15)
    v_mfma_f32_32x32x16_bf16 v[192:207], v[164:167], v[100:103], v[192:207]
    s_waitcnt lgkmcnt(2)
    v_mfma_f32_32x32x16_bf16 v[8:23], v[164:167], v[44:47], v[8:23]
    buffer_load_dwordx4 v[164:167], v1, s[12:15], s24 offen offset:1024
    ds_read_b128 v[44:47], v1 offset:12288
    s_waitcnt vmcnt(15)
    v_mfma_f32_32x32x16_bf16 v[192:207], v[168:171], v[104:107], v[192:207]
    s_waitcnt lgkmcnt(2)
    v_mfma_f32_32x32x16_bf16 v[8:23], v[168:171], v[48:51], v[8:23]
    buffer_load_dwordx4 v[168:171], v1, s[12:15], s24 offen offset:2048
    ds_read_b128 v[48:51], v1 offset:13312
    s_waitcnt vmcnt(15)
    v_mfma_f32_32x32x16_bf16 v[192:207], v[172:175], v[108:111], v[192:207]
    s_waitcnt lgkmcnt(2)
    v_mfma_f32_32x32x16_bf16 v[8:23], v[172:175], v[52:55], v[8:23]
    buffer_load_dwordx4 v[172:175], v1, s[12:15], s24 offen offset:3072
    s_add_u32 s24, s24, 4096
    ds_read_b128 v[52:55], v1 offset:14336
    s_waitcnt vmcnt(15)
    v_mfma_f32_32x32x16_bf16 v[192:207], v[176:179], v[112:115], v[192:207]
    s_waitcnt lgkmcnt(2)
    v_mfma_f32_32x32x16_bf16 v[8:23], v[176:179], v[44:47], v[8:23]
    buffer_load_dwordx4 v[176:179], v1, s[12:15], s24 offen offset:0
    ds_read_b128 v[44:47], v1 offset:15360
    s_waitcnt vmcnt(15)
    v_mfma_f32_32x32x16_bf16 v[192:207], v[180:183], v[116:119], v[192:207]
    s_waitcnt lgkmcnt(2)
    v_mfma_f32_32x32x16_bf16 v[8:23], v[180:183], v[48:51], v[8:23]
    buffer_load_dwordx4 v[180:183], v1, s[12:15], s24 offen offset:1024
    s_waitcnt vmcnt(15)
    v_mfma_f32_32x32x16_bf16 v[192:207], v[184:187], v[120:123], v[192:207]
    s_waitcnt lgkmcnt(1)
    v_mfma_f32_32x32x16_bf16 v[8:23], v[184:187], v[52:55], v[8:23]
    buffer_load_dwordx4 v[184:187], v1, s[12:15], s24 offen offset:2048
    s_waitcnt vmcnt(15)
    v_mfma_f32_32x32x16_bf16 v[192:207], v[188:191], v[124:127], v[192:207]
    s_waitcnt lgkmcnt(0)
    v_mfma_f32_32x32x16_bf16 v[8:23], v[188:191], v[44:47], v[8:23]
    buffer_load_dwordx4 v[188:191], v1, s[12:15], s24 offen offset:3072
    s_add_u32 s24, s24, 4096
    s_nop 7
    v_add_f32 v64, v192, v224
    s_nop 0
    v_add_f32 v80, v8, v26
    v_add_f32 v65, v193, v225
    v_add_f32 v81, v9, v27
    v_add_f32 v66, v194, v226
    v_add_f32 v82, v10, v28
    v_add_f32 v67, v195, v227
    v_add_f32 v83, v11, v29
    v_add_f32 v68, v196, v228
    v_add_f32 v84, v12, v30
    v_add_f32 v69, v197, v229
    v_add_f32 v85, v13, v31
    v_add_f32 v70, v198, v230
    v_add_f32 v86, v14, v32
    v_add_f32 v71, v199, v231
    v_add_f32 v87, v15, v33
    v_add_f32 v72, v200, v232
    v_add_f32 v88, v16, v34
    v_add_f32 v73, v201, v233
    v_add_f32 v89, v17, v35
    v_add_f32 v74, v202, v234
    v_add_f32 v90, v18, v36
    v_add_f32 v75, v203, v235
    v_add_f32 v91, v19, v37
    v_add_f32 v76, v204, v236
    v_add_f32 v92, v20, v38
    v_add_f32 v77, v205, v237
    v_add_f32 v93, v21, v39
    v_add_f32 v78, v206, v238
    v_add_f32 v94, v22, v40
    v_add_f32 v79, v207, v239
    v_add_f32 v95, v23, v41
    v_cvt_pk_bf16_f32 v240, v64, v65
    v_cvt_pk_bf16_f32 v241, v66, v67
    v_cvt_pk_bf16_f32 v242, v68, v69
    v_cvt_pk_bf16_f32 v243, v70, v71
    v_cvt_pk_bf16_f32 v244, v72, v73
    v_cvt_pk_bf16_f32 v245, v74, v75
    v_cvt_pk_bf16_f32 v246, v76, v77
    v_cvt_pk_bf16_f32 v247, v78, v79
    v_cvt_pk_bf16_f32 v248, v80, v81
    v_cvt_pk_bf16_f32 v249, v82, v83
    v_cvt_pk_bf16_f32 v250, v84, v85
    v_cvt_pk_bf16_f32 v251, v86, v87
    v_cvt_pk_bf16_f32 v252, v88, v89
    v_cvt_pk_bf16_f32 v253, v90, v91
    v_cvt_pk_bf16_f32 v254, v92, v93
    v_cvt_pk_bf16_f32 v255, v94, v95
    v_lshlrev_b32 v224, 16, v240
    v_and_b32 v225, 0xffff0000, v240
    v_lshlrev_b32 v226, 16, v241
    v_and_b32 v227, 0xffff0000, v241
    v_lshlrev_b32 v228, 16, v242
    v_and_b32 v229, 0xffff0000, v242
    v_lshlrev_b32 v230, 16, v243
    v_and_b32 v231, 0xffff0000, v243
    v_lshlrev_b32 v232, 16, v244
    v_and_b32 v233, 0xffff0000, v244
    v_lshlrev_b32 v234, 16, v245
    v_and_b32 v235, 0xffff0000, v245
    v_lshlrev_b32 v236, 16, v246
    v_and_b32 v237, 0xffff0000, v246
    v_lshlrev_b32 v238, 16, v247
    v_and_b32 v239, 0xffff0000, v247
    v_lshlrev_b32 v26, 16, v248
    v_and_b32 v27, 0xffff0000, v248
    v_lshlrev_b32 v28, 16, v249
    v_and_b32 v29, 0xffff0000, v249
    v_lshlrev_b32 v30, 16, v250
    v_and_b32 v31, 0xffff0000, v250
    v_lshlrev_b32 v32, 16, v251
    v_and_b32 v33, 0xffff0000, v251
    v_lshlrev_b32 v34, 16, v252
    v_and_b32 v35, 0xffff0000, v252
    v_lshlrev_b32 v36, 16, v253
    v_and_b32 v37, 0xffff0000, v253
    v_lshlrev_b32 v38, 16, v254
    v_and_b32 v39, 0xffff0000, v254
    v_lshlrev_b32 v40, 16, v255
    v_and_b32 v41, 0xffff0000, v255
    v_add_f32 v8, v224, v225
    v_add_f32 v9, v226, v227
    v_add_f32 v8, v8, v228
    v_add_f32 v9, v9, v229
    v_add_f32 v8, v8, v230
    v_add_f32 v9, v9, v231
    v_add_f32 v8, v8, v232
    v_add_f32 v9, v9, v233
    v_add_f32 v8, v8, v234
    v_add_f32 v9, v9, v235
    v_add_f32 v8, v8, v236
    v_add_f32 v9, v9, v237
    v_add_f32 v8, v8, v238
    v_add_f32 v9, v9, v239
    v_add_f32 v8, v8, v9
    v_mul_f32 v8, 0x3d800000, v8
    v_sub_f32 v10, v224, v8
    v_mul_f32 v14, v10, v10
    v_sub_f32 v11, v225, v8
    v_mul_f32 v15, v11, v11
    v_sub_f32 v12, v226, v8
    v_fma_f32 v14, v12, v12, v14
    v_sub_f32 v13, v227, v8
    v_fma_f32 v15, v13, v13, v15
    v_sub_f32 v10, v228, v8
    v_fma_f32 v14, v10, v10, v14
    v_sub_f32 v11, v229, v8
    v_fma_f32 v15, v11, v11, v15
    v_sub_f32 v12, v230, v8
    v_fma_f32 v14, v12, v12, v14
    v_sub_f32 v13, v231, v8
    v_fma_f32 v15, v13, v13, v15
    v_sub_f32 v10, v232, v8
    v_fma_f32 v14, v10, v10, v14
    v_sub_f32 v11, v233, v8
    v_fma_f32 v15, v11, v11, v15
    v_sub_f32 v12, v234, v8
    v_fma_f32 v14, v12, v12, v14
    v_sub_f32 v13, v235, v8
    v_fma_f32 v15, v13, v13, v15
    v_sub_f32 v10, v236, v8
    v_fma_f32 v14, v10, v10, v14
    v_sub_f32 v11, v237, v8
    v_fma_f32 v15, v11, v11, v15
    v_sub_f32 v12, v238, v8
    v_fma_f32 v14, v12, v12, v14
    v_sub_f32 v13, v239, v8
    v_fma_f32 v15, v13, v13, v15
    v_add_f32 v9, v14, v15
    ds_write_b64 v5, v[8:9] offset:0
    v_add_f32 v8, v26, v27
    v_add_f32 v9, v28, v29
    v_add_f32 v8, v8, v30
    v_add_f32 v9, v9, v31
    v_add_f32 v8, v8, v32
    v_add_f32 v9, v9, v33
    v_add_f32 v8, v8, v34
    v_add_f32 v9, v9, v35
    v_add_f32 v8, v8, v36
    v_add_f32 v9, v9, v37
    v_add_f32 v8, v8, v38
    v_add_f32 v9, v9, v39
    v_add_f32 v8, v8, v40
    v_add_f32 v9, v9, v41
    v_add_f32 v8, v8, v9
    v_mul_f32 v8, 0x3d800000, v8
    v_sub_f32 v10, v26, v8
    v_mul_f32 v14, v10, v10
    v_sub_f32 v11, v27, v8
    v_mul_f32 v15, v11, v11
    v_sub_f32 v12, v28, v8
    v_fma_f32 v14, v12, v12, v14
    v_sub_f32 v13, v29, v8
    v_fma_f32 v15, v13, v13, v15
    v_sub_f32 v10, v30, v8
    v_fma_f32 v14, v10, v10, v14
    v_sub_f32 v11, v31, v8
    v_fma_f32 v15, v11, v11, v15
    v_sub_f32 v12, v32, v8
    v_fma_f32 v14, v12, v12, v14
    v_sub_f32 v13, v33, v8
    v_fma_f32 v15, v13, v13, v15
    v_sub_f32 v10, v34, v8
    v_fma_f32 v14, v10, v10, v14
    v_sub_f32 v11, v35, v8
    v_fma_f32 v15, v11, v11, v15
    v_sub_f32 v12, v36, v8
    v_fma_f32 v14, v12, v12, v14
    v_sub_f32 v13, v37, v8
    v_fma_f32 v15, v13, v13, v15
    v_sub_f32 v10, v38, v8
    v_fma_f32 v14, v10, v10, v14
    v_sub_f32 v11, v39, v8
    v_fma_f32 v15, v11, v11, v15
    v_sub_f32 v12, v40, v8
    v_fma_f32 v14, v12, v12, v14
    v_sub_f32 v13, v41, v8
    v_fma_f32 v15, v13, v13, v15
    v_add_f32 v9, v14, v15
    ds_write_b64 v60, v[8:9] offset:0
    s_waitcnt lgkmcnt(0)
    s_barrier
    ds_read_b128 v[64:67], v6 offset:0
    ds_read_b128 v[68:71], v6 offset:16
    ds_read_b128 v[72:75], v6 offset:32
    ds_read_b128 v[76:79], v6 offset:48
    ds_read_b128 v[80:83], v6 offset:64
    ds_read_b128 v[84:87], v6 offset:80
    ds_read_b128 v[88:91], v6 offset:96
    ds_read_b128 v[92:95], v6 offset:112
    v_add_u32 v192, -65536, v6
    ds_read_b128 v[96:99], v192 offset:0
    ds_read_b128 v[100:103], v192 offset:16
    ds_read_b128 v[104:107], v192 offset:32
    ds_read_b128 v[108:111], v192 offset:48
    ds_read_b128 v[112:115], v192 offset:64
    ds_read_b128 v[116:119], v192 offset:80
    ds_read_b128 v[120:123], v192 offset:96
    ds_read_b128 v[124:127], v192 offset:112
    s_waitcnt lgkmcnt(15)
    v_add_f32 v8, v64, v66
    s_waitcnt lgkmcnt(14)
    v_add_f32 v9, v68, v70
    s_waitcnt lgkmcnt(13)
    v_add_f32 v8, v8, v72
    v_add_f32 v9, v9, v74
    s_waitcnt lgkmcnt(12)
    v_add_f32 v8, v8, v76
    v_add_f32 v9, v9, v78
    s_waitcnt lgkmcnt(11)
    v_add_f32 v8, v8, v80
    v_add_f32 v9, v9, v82
    s_waitcnt lgkmcnt(10)
    v_add_f32 v8, v8, v84
    v_add_f32 v9, v9, v86
    s_waitcnt lgkmcnt(9)
    v_add_f32 v8, v8, v88
    v_add_f32 v9, v9, v90
    s_waitcnt lgkmcnt(8)
    v_add_f32 v8, v8, v92
    v_add_f32 v9, v9, v94
    v_add_f32 v8, v8, v9
    v_mul_f32 v8, 0x3d800000, v8
    v_add_f32 v9, v65, v67
    v_add_f32 v10, v69, v71
    v_add_f32 v9, v9, v73
    v_add_f32 v10, v10, v75
    v_add_f32 v9, v9, v77
    v_add_f32 v10, v10, v79
    v_add_f32 v9, v9, v81
    v_add_f32 v10, v10, v83
    v_add_f32 v9, v9, v85
    v_add_f32 v10, v10, v87
    v_add_f32 v9, v9, v89
    v_add_f32 v10, v10, v91
    v_add_f32 v9, v9, v93
    v_add_f32 v10, v10, v95
    v_add_f32 v9, v9, v10
    v_sub_f32 v12, v64, v8
    v_mul_f32 v10, v12, v12
    v_sub_f32 v13, v66, v8
    v_mul_f32 v11, v13, v13
    v_sub_f32 v14, v68, v8
    v_fma_f32 v10, v14, v14, v10
    v_sub_f32 v15, v70, v8
    v_fma_f32 v11, v15, v15, v11
    v_sub_f32 v12, v72, v8
    v_fma_f32 v10, v12, v12, v10
    v_sub_f32 v13, v74, v8
    v_fma_f32 v11, v13, v13, v11
    v_sub_f32 v14, v76, v8
    v_fma_f32 v10, v14, v14, v10
    v_sub_f32 v15, v78, v8
    v_fma_f32 v11, v15, v15, v11
    v_sub_f32 v12, v80, v8
    v_fma_f32 v10, v12, v12, v10
    v_sub_f32 v13, v82, v8
    v_fma_f32 v11, v13, v13, v11
    v_sub_f32 v14, v84, v8
    v_fma_f32 v10, v14, v14, v10
    v_sub_f32 v15, v86, v8
    v_fma_f32 v11, v15, v15, v11
    v_sub_f32 v12, v88, v8
    v_fma_f32 v10, v12, v12, v10
    v_sub_f32 v13, v90, v8
    v_fma_f32 v11, v13, v13, v11
    v_sub_f32 v14, v92, v8
    v_fma_f32 v10, v14, v14, v10
    v_sub_f32 v15, v94, v8
    v_fma_f32 v11, v15, v15, v11
    v_add_f32 v10, v10, v11
    v_mov_b32 v11, 0x41800000
    v_fma_f32 v9, v10, v11, v9
    v_mul_f32 v9, 0x3b800000, v9
    v_cvt_pk_bf16_f32 v10, v8, v9
    v_lshlrev_b32 v8, 16, v10
    v_and_b32 v9, 0xffff0000, v10
    v_add_f32 v9, 0x3727c5ac, v9
    v_cvt_pk_bf16_f32 v9, v9, v9
    v_lshlrev_b32 v9, 16, v9
    v_sqrt_f32 v9, v9
    s_nop 0
    v_cvt_pk_bf16_f32 v9, v9, v9
    v_lshlrev_b32 v9, 16, v9
    v_rcp_f32 v9, v9
    v_sub_f32 v10, v224, v8
    v_sub_f32 v11, v225, v8
    v_sub_f32 v12, v226, v8
    v_sub_f32 v13, v227, v8
    v_sub_f32 v14, v228, v8
    v_sub_f32 v15, v229, v8
    v_sub_f32 v16, v230, v8
    v_sub_f32 v17, v231, v8
    v_sub_f32 v18, v232, v8
    v_sub_f32 v19, v233, v8
    v_sub_f32 v20, v234, v8
    v_sub_f32 v21, v235, v8
    v_sub_f32 v22, v236, v8
    v_sub_f32 v23, v237, v8
    v_sub_f32 v24, v238, v8
    v_sub_f32 v25, v239, v8
    v_mul_f32 v10, v10, v9
    v_mul_f32 v11, v11, v9
    v_mul_f32 v12, v12, v9
    v_mul_f32 v13, v13, v9
    v_mul_f32 v14, v14, v9
    v_mul_f32 v15, v15, v9
    v_mul_f32 v16, v16, v9
    v_mul_f32 v17, v17, v9
    v_mul_f32 v18, v18, v9
    v_mul_f32 v19, v19, v9
    v_mul_f32 v20, v20, v9
    v_mul_f32 v21, v21, v9
    v_mul_f32 v22, v22, v9
    v_mul_f32 v23, v23, v9
    v_mul_f32 v24, v24, v9
    v_mul_f32 v25, v25, v9
    v_cvt_pk_bf16_f32 v240, v10, v11
    v_cvt_pk_bf16_f32 v241, v12, v13
    v_cvt_pk_bf16_f32 v242, v14, v15
    v_cvt_pk_bf16_f32 v243, v16, v17
    v_cvt_pk_bf16_f32 v244, v18, v19
    v_cvt_pk_bf16_f32 v245, v20, v21
    v_cvt_pk_bf16_f32 v246, v22, v23
    v_cvt_pk_bf16_f32 v247, v24, v25
    s_waitcnt lgkmcnt(7)
    v_add_f32 v8, v96, v98
    s_waitcnt lgkmcnt(6)
    v_add_f32 v9, v100, v102
    s_waitcnt lgkmcnt(5)
    v_add_f32 v8, v8, v104
    v_add_f32 v9, v9, v106
    s_waitcnt lgkmcnt(4)
    v_add_f32 v8, v8, v108
    v_add_f32 v9, v9, v110
    s_waitcnt lgkmcnt(3)
    v_add_f32 v8, v8, v112
    v_add_f32 v9, v9, v114
    s_waitcnt lgkmcnt(2)
    v_add_f32 v8, v8, v116
    v_add_f32 v9, v9, v118
    s_waitcnt lgkmcnt(1)
    v_add_f32 v8, v8, v120
    v_add_f32 v9, v9, v122
    s_waitcnt lgkmcnt(0)
    v_add_f32 v8, v8, v124
    v_add_f32 v9, v9, v126
    v_add_f32 v8, v8, v9
    v_mul_f32 v8, 0x3d800000, v8
    v_add_f32 v9, v97, v99
    v_add_f32 v10, v101, v103
    v_add_f32 v9, v9, v105
    v_add_f32 v10, v10, v107
    v_add_f32 v9, v9, v109
    v_add_f32 v10, v10, v111
    v_add_f32 v9, v9, v113
    v_add_f32 v10, v10, v115
    v_add_f32 v9, v9, v117
    v_add_f32 v10, v10, v119
    v_add_f32 v9, v9, v121
    v_add_f32 v10, v10, v123
    v_add_f32 v9, v9, v125
    v_add_f32 v10, v10, v127
    v_add_f32 v9, v9, v10
    v_sub_f32 v12, v96, v8
    v_mul_f32 v10, v12, v12
    v_sub_f32 v13, v98, v8
    v_mul_f32 v11, v13, v13
    v_sub_f32 v14, v100, v8
    v_fma_f32 v10, v14, v14, v10
    v_sub_f32 v15, v102, v8
    v_fma_f32 v11, v15, v15, v11
    v_sub_f32 v12, v104, v8
    v_fma_f32 v10, v12, v12, v10
    v_sub_f32 v13, v106, v8
    v_fma_f32 v11, v13, v13, v11
    v_sub_f32 v14, v108, v8
    v_fma_f32 v10, v14, v14, v10
    v_sub_f32 v15, v110, v8
    v_fma_f32 v11, v15, v15, v11
    v_sub_f32 v12, v112, v8
    v_fma_f32 v10, v12, v12, v10
    v_sub_f32 v13, v114, v8
    v_fma_f32 v11, v13, v13, v11
    v_sub_f32 v14, v116, v8
    v_fma_f32 v10, v14, v14, v10
    v_sub_f32 v15, v118, v8
    v_fma_f32 v11, v15, v15, v11
    v_sub_f32 v12, v120, v8
    v_fma_f32 v10, v12, v12, v10
    v_sub_f32 v13, v122, v8
    v_fma_f32 v11, v13, v13, v11
    v_sub_f32 v14, v124, v8
    v_fma_f32 v10, v14, v14, v10
    v_sub_f32 v15, v126, v8
    v_fma_f32 v11, v15, v15, v11
    v_add_f32 v10, v10, v11
    v_mov_b32 v11, 0x41800000
    v_fma_f32 v9, v10, v11, v9
    v_mul_f32 v9, 0x3b800000, v9
    v_cvt_pk_bf16_f32 v10, v8, v9
    v_lshlrev_b32 v8, 16, v10
    v_and_b32 v9, 0xffff0000, v10
    v_add_f32 v9, 0x3727c5ac, v9
    v_cvt_pk_bf16_f32 v9, v9, v9
    v_lshlrev_b32 v9, 16, v9
    v_sqrt_f32 v9, v9
    s_nop 0
    v_cvt_pk_bf16_f32 v9, v9, v9
    v_lshlrev_b32 v9, 16, v9
    v_rcp_f32 v9, v9
    v_sub_f32 v10, v26, v8
    v_sub_f32 v11, v27, v8
    v_sub_f32 v12, v28, v8
    v_sub_f32 v13, v29, v8
    v_sub_f32 v14, v30, v8
    v_sub_f32 v15, v31, v8
    v_sub_f32 v16, v32, v8
    v_sub_f32 v17, v33, v8
    v_sub_f32 v18, v34, v8
    v_sub_f32 v19, v35, v8
    v_sub_f32 v20, v36, v8
    v_sub_f32 v21, v37, v8
    v_sub_f32 v22, v38, v8
    v_sub_f32 v23, v39, v8
    v_sub_f32 v24, v40, v8
    v_sub_f32 v25, v41, v8
    v_mul_f32 v10, v10, v9
    v_mul_f32 v11, v11, v9
    v_mul_f32 v12, v12, v9
    v_mul_f32 v13, v13, v9
    v_mul_f32 v14, v14, v9
    v_mul_f32 v15, v15, v9
    v_mul_f32 v16, v16, v9
    v_mul_f32 v17, v17, v9
    v_mul_f32 v18, v18, v9
    v_mul_f32 v19, v19, v9
    v_mul_f32 v20, v20, v9
    v_mul_f32 v21, v21, v9
    v_mul_f32 v22, v22, v9
    v_mul_f32 v23, v23, v9
    v_mul_f32 v24, v24, v9
    v_mul_f32 v25, v25, v9
    v_cvt_pk_bf16_f32 v248, v10, v11
    v_cvt_pk_bf16_f32 v249, v12, v13
    v_cvt_pk_bf16_f32 v250, v14, v15
    v_cvt_pk_bf16_f32 v251, v16, v17
    v_cvt_pk_bf16_f32 v252, v18, v19
    v_cvt_pk_bf16_f32 v253, v20, v21
    v_cvt_pk_bf16_f32 v254, v22, v23
    v_cvt_pk_bf16_f32 v255, v24, v25
    ds_write_b128 v3, v[240:243]
    ds_write_b128 v3, v[244:247] offset:1024
    ds_write_b128 v61, v[248:251]
    ds_write_b128 v61, v[252:255] offset:1024
    s_waitcnt lgkmcnt(0)
    s_barrier
    ds_read_b128 v[64:67], v2 offset:0
    ds_read_b128 v[68:71], v2 offset:1024
    ds_read_b128 v[72:75], v2 offset:2048
    ds_read_b128 v[76:79], v2 offset:3072
    ds_read_b128 v[80:83], v2 offset:4096
    ds_read_b128 v[84:87], v2 offset:5120
    ds_read_b128 v[88:91], v2 offset:6144
    ds_read_b128 v[92:95], v2 offset:7168
    ds_read_b128 v[96:99], v2 offset:8192
    ds_read_b128 v[100:103], v2 offset:9216
    ds_read_b128 v[104:107], v2 offset:10240
    ds_read_b128 v[108:111], v2 offset:11264
    ds_read_b128 v[112:115], v2 offset:12288
    ds_read_b128 v[116:119], v2 offset:13312
    ds_read_b128 v[120:123], v2 offset:14336
    ds_read_b128 v[124:127], v2 offset:15360
    ds_read_b128 v[44:47], v1 offset:0
    ds_read_b128 v[48:51], v1 offset:1024
    ds_read_b128 v[52:55], v1 offset:2048
    s_waitcnt vmcnt(15) lgkmcnt(15)
    v_mfma_f32_32x32x16_bf16 v[192:207], v[128:131], v[64:67], 0
    s_waitcnt lgkmcnt(2)
    v_mfma_f32_32x32x16_bf16 v[8:23], v[128:131], v[44:47], 0
    buffer_load_dwordx4 v[128:131], v1, s[12:15], s24 offen offset:0
    ds_read_b128 v[44:47], v1 offset:3072
    s_waitcnt vmcnt(15)
    v_mfma_f32_32x32x16_bf16 v[192:207], v[132:135], v[68:71], v[192:207]
    s_waitcnt lgkmcnt(2)
    v_mfma_f32_32x32x16_bf16 v[8:23], v[132:135], v[48:51], v[8:23]
    buffer_load_dwordx4 v[132:135], v1, s[12:15], s24 offen offset:1024
    ds_read_b128 v[48:51], v1 offset:4096
    s_waitcnt vmcnt(15)
    v_mfma_f32_32x32x16_bf16 v[192:207], v[136:139], v[72:75], v[192:207]
    s_waitcnt lgkmcnt(2)
    v_mfma_f32_32x32x16_bf16 v[8:23], v[136:139], v[52:55], v[8:23]
    buffer_load_dwordx4 v[136:139], v1, s[12:15], s24 offen offset:2048
    ds_read_b128 v[52:55], v1 offset:5120
    s_waitcnt vmcnt(15)
    v_mfma_f32_32x32x16_bf16 v[192:207], v[140:143], v[76:79], v[192:207]
    s_waitcnt lgkmcnt(2)
    v_mfma_f32_32x32x16_bf16 v[8:23], v[140:143], v[44:47], v[8:23]
    buffer_load_dwordx4 v[140:143], v1, s[12:15], s24 offen offset:3072
    s_add_u32 s24, s24, 4096
    ds_read_b128 v[44:47], v1 offset:6144
    s_waitcnt vmcnt(15)
    v_mfma_f32_32x32x16_bf16 v[192:207], v[144:147], v[80:83], v[192:207]
    s_waitcnt lgkmcnt(2)
    v_mfma_f32_32x32x16_bf16 v[8:23], v[144:147], v[48:51], v[8:23]
    buffer_load_dwordx4 v[144:147], v1, s[12:15], s24 offen offset:0
    ds_read_b128 v[48:51], v1 offset:7168
    s_waitcnt vmcnt(15)
    v_mfma_f32_32x32x16_bf16 v[192:207], v[148:151], v[84:87], v[192:207]
    s_waitcnt lgkmcnt(2)
    v_mfma_f32_32x32x16_bf16 v[8:23], v[148:151], v[52:55], v[8:23]
    buffer_load_dwordx4 v[148:151], v1, s[12:15], s24 offen offset:1024
    ds_read_b128 v[52:55], v1 offset:8192
    s_waitcnt vmcnt(15)
    v_mfma_f32_32x32x16_bf16 v[192:207], v[152:155], v[88:91], v[192:207]
    s_waitcnt lgkmcnt(2)
    v_mfma_f32_32x32x16_bf16 v[8:23], v[152:155], v[44:47], v[8:23]
    buffer_load_dwordx4 v[152:155], v1, s[12:15], s24 offen offset:2048
    ds_read_b128 v[44:47], v1 offset:9216
    s_waitcnt vmcnt(15)
    v_mfma_f32_32x32x16_bf16 v[192:207], v[156:159], v[92:95], v[192:207]
    s_waitcnt lgkmcnt(2)
    v_mfma_f32_32x32x16_bf16 v[8:23], v[156:159], v[48:51], v[8:23]
    buffer_load_dwordx4 v[156:159], v1, s[12:15], s24 offen offset:3072
    s_add_u32 s24, s24, 4096
    ds_read_b128 v[48:51], v1 offset:10240
    s_waitcnt vmcnt(15)
    v_mfma_f32_32x32x16_bf16 v[192:207], v[160:163], v[96:99], v[192:207]
    s_waitcnt lgkmcnt(2)
    v_mfma_f32_32x32x16_bf16 v[8:23], v[160:163], v[52:55], v[8:23]
    buffer_load_dwordx4 v[160:163], v1, s[12:15], s24 offen offset:0
    ds_read_b128 v[52:55], v1 offset:11264
    s_waitcnt vmcnt(15)
    v_mfma_f32_32x32x16_bf16 v[192:207], v[164:167], v[100:103], v[192:207]
    s_waitcnt lgkmcnt(2)
    v_mfma_f32_32x32x16_bf16 v[8:23], v[164:167], v[44:47], v[8:23]
    buffer_load_dwordx4 v[164:167], v1, s[12:15], s24 offen offset:1024
    ds_read_b128 v[44:47], v1 offset:12288
    s_waitcnt vmcnt(15)
    v_mfma_f32_32x32x16_bf16 v[192:207], v[168:171], v[104:107], v[192:207]
    s_waitcnt lgkmcnt(2)
    v_mfma_f32_32x32x16_bf16 v[8:23], v[168:171], v[48:51], v[8:23]
    buffer_load_dwordx4 v[168:171], v1, s[12:15], s24 offen offset:2048
    ds_read_b128 v[48:51], v1 offset:13312
    s_waitcnt vmcnt(15)
    v_mfma_f32_32x32x16_bf16 v[192:207], v[172:175], v[108:111], v[192:207]
    s_waitcnt lgkmcnt(2)
    v_mfma_f32_32x32x16_bf16 v[8:23], v[172:175], v[52:55], v[8:23]
    buffer_load_dwordx4 v[172:175], v1, s[12:15], s24 offen offset:3072
    s_add_u32 s24, s24, 4096
    ds_read_b128 v[52:55], v1 offset:14336
    s_waitcnt vmcnt(15)
    v_mfma_f32_32x32x16_bf16 v[192:207], v[176:179], v[112:115], v[192:207]
    s_waitcnt lgkmcnt(2)
    v_mfma_f32_32x32x16_bf16 v[8:23], v[176:179], v[44:47], v[8:23]
    buffer_load_dwordx4 v[176:179], v1, s[12:15], s24 offen offset:0
    ds_read_b128 v[44:47], v1 offset:15360
    s_waitcnt vmcnt(15)
    v_mfma_f32_32x32x16_bf16 v[192:207], v[180:183], v[116:119], v[192:207]
    s_waitcnt lgkmcnt(2)
    v_mfma_f32_32x32x16_bf16 v[8:23], v[180:183], v[48:51], v[8:23]
    buffer_load_dwordx4 v[180:183], v1, s[12:15], s24 offen offset:1024
    s_waitcnt vmcnt(15)
    v_mfma_f32_32x32x16_bf16 v[192:207], v[184:187], v[120:123], v[192:207]
    s_waitcnt lgkmcnt(1)
    v_mfma_f32_32x32x16_bf16 v[8:23], v[184:187], v[52:55], v[8:23]
    buffer_load_dwordx4 v[184:187], v1, s[12:15], s24 offen offset:2048
    s_waitcnt vmcnt(15)
    v_mfma_f32_32x32x16_bf16 v[192:207], v[188:191], v[124:127], v[192:207]
    s_waitcnt lgkmcnt(0)
    v_mfma_f32_32x32x16_bf16 v[8:23], v[188:191], v[44:47], v[8:23]
    buffer_load_dwordx4 v[188:191], v1, s[12:15], s24 offen offset:3072
    s_add_u32 s24, s24, 4096
    ds_read_b128 v[44:47], v1 offset:0
    ds_read_b128 v[48:51], v1 offset:1024
    ds_read_b128 v[52:55], v1 offset:2048
    s_waitcnt vmcnt(15)
    v_mfma_f32_32x32x16_bf16 v[208:223], v[128:131], v[64:67], 0
    s_waitcnt lgkmcnt(2)
    v_mfma_f32_32x32x16_bf16 v[24:39], v[128:131], v[44:47], 0
    s_mul_i32 s24, s3, 147456
    s_add_u32 s24, s24, 1835008
    buffer_load_dwordx4 v[128:131], v1, s[12:15], s24 offen offset:0
    ds_read_b128 v[44:47], v1 offset:3072
    s_waitcnt vmcnt(15)
    v_mfma_f32_32x32x16_bf16 v[208:223], v[132:135], v[68:71], v[208:223]
    s_waitcnt lgkmcnt(2)
    v_mfma_f32_32x32x16_bf16 v[24:39], v[132:135], v[48:51], v[24:39]
    buffer_load_dwordx4 v[132:135], v1, s[12:15], s24 offen offset:1024
    ds_read_b128 v[48:51], v1 offset:4096
    s_waitcnt vmcnt(15)
    v_mfma_f32_32x32x16_bf16 v[208:223], v[136:139], v[72:75], v[208:223]
    s_waitcnt lgkmcnt(2)
    v_mfma_f32_32x32x16_bf16 v[24:39], v[136:139], v[52:55], v[24:39]
    buffer_load_dwordx4 v[136:139], v1, s[12:15], s24 offen offset:2048
    ds_read_b128 v[52:55], v1 offset:5120
    s_waitcnt vmcnt(15)
    v_mfma_f32_32x32x16_bf16 v[208:223], v[140:143], v[76:79], v[208:223]
    s_waitcnt lgkmcnt(2)
    v_mfma_f32_32x32x16_bf16 v[24:39], v[140:143], v[44:47], v[24:39]
    buffer_load_dwordx4 v[140:143], v1, s[12:15], s24 offen offset:3072
    s_add_u32 s24, s24, 4096
    ds_read_b128 v[44:47], v1 offset:6144
    s_waitcnt vmcnt(15)
    v_mfma_f32_32x32x16_bf16 v[208:223], v[144:147], v[80:83], v[208:223]
    s_waitcnt lgkmcnt(2)
    v_mfma_f32_32x32x16_bf16 v[24:39], v[144:147], v[48:51], v[24:39]
    buffer_load_dwordx4 v[144:147], v1, s[12:15], s24 offen offset:0
    ds_read_b128 v[48:51], v1 offset:7168
    s_waitcnt vmcnt(15)
    v_mfma_f32_32x32x16_bf16 v[208:223], v[148:151], v[84:87], v[208:223]
    s_waitcnt lgkmcnt(2)
    v_mfma_f32_32x32x16_bf16 v[24:39], v[148:151], v[52:55], v[24:39]
    buffer_load_dwordx4 v[148:151], v1, s[12:15], s24 offen offset:1024
    ds_read_b128 v[52:55], v1 offset:8192
    s_waitcnt vmcnt(15)
    v_mfma_f32_32x32x16_bf16 v[208:223], v[152:155], v[88:91], v[208:223]
    s_waitcnt lgkmcnt(2)
    v_mfma_f32_32x32x16_bf16 v[24:39], v[152:155], v[44:47], v[24:39]
    buffer_load_dwordx4 v[152:155], v1, s[12:15], s24 offen offset:2048
    ds_read_b128 v[44:47], v1 offset:9216
    s_waitcnt vmcnt(15)
    v_mfma_f32_32x32x16_bf16 v[208:223], v[156:159], v[92:95], v[208:223]
    s_waitcnt lgkmcnt(2)
    v_mfma_f32_32x32x16_bf16 v[24:39], v[156:159], v[48:51], v[24:39]
    buffer_load_dwordx4 v[156:159], v1, s[12:15], s24 offen offset:3072
    s_add_u32 s24, s24, 4096
    ds_read_b128 v[48:51], v1 offset:10240
    s_waitcnt vmcnt(15)
    v_mfma_f32_32x32x16_bf16 v[208:223], v[160:163], v[96:99], v[208:223]
    s_waitcnt lgkmcnt(2)
    v_mfma_f32_32x32x16_bf16 v[24:39], v[160:163], v[52:55], v[24:39]
    buffer_load_dwordx4 v[160:163], v1, s[12:15], s24 offen offset:0
    ds_read_b128 v[52:55], v1 offset:11264
    s_waitcnt vmcnt(15)
    v_mfma_f32_32x32x16_bf16 v[208:223], v[164:167], v[100:103], v[208:223]
    s_waitcnt lgkmcnt(2)
    v_mfma_f32_32x32x16_bf16 v[24:39], v[164:167], v[44:47], v[24:39]
    buffer_load_dwordx4 v[164:167], v1, s[12:15], s24 offen offset:1024
    ds_read_b128 v[44:47], v1 offset:12288
    s_waitcnt vmcnt(15)
    v_mfma_f32_32x32x16_bf16 v[208:223], v[168:171], v[104:107], v[208:223]
    s_waitcnt lgkmcnt(2)
    v_mfma_f32_32x32x16_bf16 v[24:39], v[168:171], v[48:51], v[24:39]
    buffer_load_dwordx4 v[168:171], v1, s[12:15], s24 offen offset:2048
    ds_read_b128 v[48:51], v1 offset:13312
    s_waitcnt vmcnt(15)
    v_mfma_f32_32x32x16_bf16 v[208:223], v[172:175], v[108:111], v[208:223]
    s_waitcnt lgkmcnt(2)
    v_mfma_f32_32x32x16_bf16 v[24:39], v[172:175], v[52:55], v[24:39]
    buffer_load_dwordx4 v[172:175], v1, s[12:15], s24 offen offset:3072
    s_add_u32 s24, s24, 4096
    ds_read_b128 v[52:55], v1 offset:14336
    s_waitcnt vmcnt(15)
    v_mfma_f32_32x32x16_bf16 v[208:223], v[176:179], v[112:115], v[208:223]
    s_waitcnt lgkmcnt(2)
    v_mfma_f32_32x32x16_bf16 v[24:39], v[176:179], v[44:47], v[24:39]
    buffer_load_dwordx4 v[176:179], v1, s[12:15], s24 offen offset:0
    ds_read_b128 v[44:47], v1 offset:15360
    s_waitcnt vmcnt(15)
    v_mfma_f32_32x32x16_bf16 v[208:223], v[180:183], v[116:119], v[208:223]
    s_waitcnt lgkmcnt(2)
    v_mfma_f32_32x32x16_bf16 v[24:39], v[180:183], v[48:51], v[24:39]
    buffer_load_dwordx4 v[180:183], v1, s[12:15], s24 offen offset:1024
    s_waitcnt vmcnt(15)
    v_mfma_f32_32x32x16_bf16 v[208:223], v[184:187], v[120:123], v[208:223]
    s_waitcnt lgkmcnt(1)
    v_mfma_f32_32x32x16_bf16 v[24:39], v[184:187], v[52:55], v[24:39]
    buffer_load_dwordx4 v[184:187], v1, s[12:15], s24 offen offset:2048
    s_waitcnt vmcnt(15)
    v_mfma_f32_32x32x16_bf16 v[208:223], v[188:191], v[124:127], v[208:223]
    s_waitcnt lgkmcnt(0)
    v_mfma_f32_32x32x16_bf16 v[24:39], v[188:191], v[44:47], v[24:39]
    buffer_load_dwordx4 v[188:191], v1, s[12:15], s24 offen offset:3072
    s_add_u32 s24, s24, 4096
    v_lshrrev_b32 v62, 9, v1
    v_lshlrev_b32 v62, 3, v62
    s_lshl_b32 s25, s3, 6
    s_add_u32 s25, s25, 86528
    v_add_u32 v62, s25, v62
    ds_read_b64 v[88:89], v62 offset:0
    ds_read_b64 v[90:91], v62 offset:16
    ds_read_b64 v[92:93], v62 offset:32
    ds_read_b64 v[94:95], v62 offset:48
    ds_read_b64 v[96:97], v62 offset:512
    ds_read_b64 v[98:99], v62 offset:528
    ds_read_b64 v[100:101], v62 offset:544
    ds_read_b64 v[102:103], v62 offset:560
    ds_read_b64 v[104:105], v62 offset:1024
    ds_read_b64 v[106:107], v62 offset:1040
    ds_read_b64 v[108:109], v62 offset:1056
    ds_read_b64 v[110:111], v62 offset:1072
    ds_read_b64 v[112:113], v62 offset:1536
    ds_read_b64 v[114:115], v62 offset:1552
    ds_read_b64 v[116:117], v62 offset:1568
    ds_read_b64 v[118:119], v62 offset:1584
    ds_read_b64 v[120:121], v62 offset:2048
    ds_read_b64 v[122:123], v62 offset:2064
    ds_read_b64 v[124:125], v62 offset:2080
    ds_read_b64 v[126:127], v62 offset:2096
    v_cvt_pk_bf16_f32 v80, v208, v209
    v_cvt_pk_bf16_f32 v81, v210, v211
    v_cvt_pk_bf16_f32 v82, v212, v213
    v_cvt_pk_bf16_f32 v83, v214, v215
    v_cvt_pk_bf16_f32 v84, v216, v217
    v_cvt_pk_bf16_f32 v85, v218, v219
    v_cvt_pk_bf16_f32 v86, v220, v221
    v_cvt_pk_bf16_f32 v87, v222, v223
    v_lshlrev_b32 v64, 16, v80
    v_and_b32 v65, 0xffff0000, v80
    v_lshlrev_b32 v66, 16, v81
    v_and_b32 v67, 0xffff0000, v81
    v_lshlrev_b32 v68, 16, v82
    v_and_b32 v69, 0xffff0000, v82
    v_lshlrev_b32 v70, 16, v83
    v_and_b32 v71, 0xffff0000, v83
    v_lshlrev_b32 v72, 16, v84
    v_and_b32 v73, 0xffff0000, v84
    v_lshlrev_b32 v74, 16, v85
    v_and_b32 v75, 0xffff0000, v85
    v_lshlrev_b32 v76, 16, v86
    v_and_b32 v77, 0xffff0000, v86
    v_lshlrev_b32 v78, 16, v87
    v_and_b32 v79, 0xffff0000, v87
    v_mul_f32 v64, 0xbfb8aa3b, v64
    v_mul_f32 v65, 0xbfb8aa3b, v65
    v_mul_f32 v66, 0xbfb8aa3b, v66
    v_mul_f32 v67, 0xbfb8aa3b, v67
    v_mul_f32 v68, 0xbfb8aa3b, v68
    v_mul_f32 v69, 0xbfb8aa3b, v69
    v_mul_f32 v70, 0xbfb8aa3b, v70
    v_mul_f32 v71, 0xbfb8aa3b, v71
    v_mul_f32 v72, 0xbfb8aa3b, v72
    v_mul_f32 v73, 0xbfb8aa3b, v73
    v_mul_f32 v74, 0xbfb8aa3b, v74
    v_mul_f32 v75, 0xbfb8aa3b, v75
    v_mul_f32 v76, 0xbfb8aa3b, v76
    v_mul_f32 v77, 0xbfb8aa3b, v77
    v_mul_f32 v78, 0xbfb8aa3b, v78
    v_mul_f32 v79, 0xbfb8aa3b, v79
    v_exp_f32 v64, v64
    v_exp_f32 v65, v65
    v_exp_f32 v66, v66
    v_exp_f32 v67, v67
    v_exp_f32 v68, v68
    v_exp_f32 v69, v69
    v_exp_f32 v70, v70
    v_exp_f32 v71, v71
    v_exp_f32 v72, v72
    v_exp_f32 v73, v73
    v_exp_f32 v74, v74
    v_exp_f32 v75, v75
    v_exp_f32 v76, v76
    v_exp_f32 v77, v77
    v_exp_f32 v78, v78
    v_exp_f32 v79, v79
    v_add_f32 v64, 1.0, v64
    v_add_f32 v65, 1.0, v65
    v_add_f32 v66, 1.0, v66
    v_add_f32 v67, 1.0, v67
    v_add_f32 v68, 1.0, v68
    v_add_f32 v69, 1.0, v69
    v_add_f32 v70, 1.0, v70
    v_add_f32 v71, 1.0, v71
    v_add_f32 v72, 1.0, v72
    v_add_f32 v73, 1.0, v73
    v_add_f32 v74, 1.0, v74
    v_add_f32 v75, 1.0, v75
    v_add_f32 v76, 1.0, v76
    v_add_f32 v77, 1.0, v77
    v_add_f32 v78, 1.0, v78
    v_add_f32 v79, 1.0, v79
    v_rcp_f32 v64, v64
    v_rcp_f32 v65, v65
    v_rcp_f32 v66, v66
    v_rcp_f32 v67, v67
    v_rcp_f32 v68, v68
    v_rcp_f32 v69, v69
    v_rcp_f32 v70, v70
    v_rcp_f32 v71, v71
    v_rcp_f32 v72, v72
    v_rcp_f32 v73, v73
    v_rcp_f32 v74, v74
    v_rcp_f32 v75, v75
    v_rcp_f32 v76, v76
    v_rcp_f32 v77, v77
    v_rcp_f32 v78, v78
    v_rcp_f32 v79, v79
    v_cvt_pk_bf16_f32 v80, v192, v193
    v_cvt_pk_bf16_f32 v81, v194, v195
    v_cvt_pk_bf16_f32 v82, v196, v197
    v_cvt_pk_bf16_f32 v83, v198, v199
    v_cvt_pk_bf16_f32 v84, v200, v201
    v_cvt_pk_bf16_f32 v85, v202, v203
    v_cvt_pk_bf16_f32 v86, v204, v205
    v_cvt_pk_bf16_f32 v87, v206, v207
    v_lshlrev_b32 v208, 16, v80
    v_and_b32 v209, 0xffff0000, v80
    v_lshlrev_b32 v210, 16, v81
    v_and_b32 v211, 0xffff0000, v81
    v_lshlrev_b32 v212, 16, v82
    v_and_b32 v213, 0xffff0000, v82
    v_lshlrev_b32 v214, 16, v83
    v_and_b32 v215, 0xffff0000, v83
    v_lshlrev_b32 v216, 16, v84
    v_and_b32 v217, 0xffff0000, v84
    v_lshlrev_b32 v218, 16, v85
    v_and_b32 v219, 0xffff0000, v85
    v_lshlrev_b32 v220, 16, v86
    v_and_b32 v221, 0xffff0000, v86
    v_lshlrev_b32 v222, 16, v87
    v_and_b32 v223, 0xffff0000, v87
    v_mul_f32 v64, v64, v208
    v_mul_f32 v65, v65, v209
    v_mul_f32 v66, v66, v210
    v_mul_f32 v67, v67, v211
    v_mul_f32 v68, v68, v212
    v_mul_f32 v69, v69, v213
    v_mul_f32 v70, v70, v214
    v_mul_f32 v71, v71, v215
    v_mul_f32 v72, v72, v216
    v_mul_f32 v73, v73, v217
    v_mul_f32 v74, v74, v218
    v_mul_f32 v75, v75, v219
    v_mul_f32 v76, v76, v220
    v_mul_f32 v77, v77, v221
    v_mul_f32 v78, v78, v222
    v_mul_f32 v79, v79, v223
    v_cvt_pk_bf16_f32 v240, v64, v65
    v_cvt_pk_bf16_f32 v241, v66, v67
    v_cvt_pk_bf16_f32 v242, v68, v69
    v_cvt_pk_bf16_f32 v243, v70, v71
    v_cvt_pk_bf16_f32 v244, v72, v73
    v_cvt_pk_bf16_f32 v245, v74, v75
    v_cvt_pk_bf16_f32 v246, v76, v77
    v_cvt_pk_bf16_f32 v247, v78, v79
    v_mul_f32 v8, v8, v57
    v_mul_f32 v24, v24, v57
    v_mul_f32 v9, v9, v57
    v_mul_f32 v25, v25, v57
    v_mul_f32 v10, v10, v57
    v_mul_f32 v26, v26, v57
    v_mul_f32 v11, v11, v57
    v_mul_f32 v27, v27, v57
    v_mul_f32 v12, v12, v57
    v_mul_f32 v28, v28, v57
    v_mul_f32 v13, v13, v57
    v_mul_f32 v29, v29, v57
    v_mul_f32 v14, v14, v57
    v_mul_f32 v30, v30, v57
    v_mul_f32 v15, v15, v57
    v_mul_f32 v31, v31, v57
    v_mul_f32 v16, v16, v57
    v_mul_f32 v32, v32, v57
    v_mul_f32 v17, v17, v57
    v_mul_f32 v33, v33, v57
    v_mul_f32 v18, v18, v57
    v_mul_f32 v34, v34, v57
    v_mul_f32 v19, v19, v57
    v_mul_f32 v35, v35, v57
    v_mul_f32 v20, v20, v57
    v_mul_f32 v36, v36, v57
    v_mul_f32 v21, v21, v57
    v_mul_f32 v37, v37, v57
    v_mul_f32 v22, v22, v57
    v_mul_f32 v38, v38, v57
    v_mul_f32 v23, v23, v57
    v_mul_f32 v39, v39, v57
    v_cvt_pk_bf16_f32 v80, v24, v25
    v_cvt_pk_bf16_f32 v81, v26, v27
    v_cvt_pk_bf16_f32 v82, v28, v29
    v_cvt_pk_bf16_f32 v83, v30, v31
    v_cvt_pk_bf16_f32 v84, v32, v33
    v_cvt_pk_bf16_f32 v85, v34, v35
    v_cvt_pk_bf16_f32 v86, v36, v37
    v_cvt_pk_bf16_f32 v87, v38, v39
    v_lshlrev_b32 v64, 16, v80
    v_and_b32 v65, 0xffff0000, v80
    v_lshlrev_b32 v66, 16, v81
    v_and_b32 v67, 0xffff0000, v81
    v_lshlrev_b32 v68, 16, v82
    v_and_b32 v69, 0xffff0000, v82
    v_lshlrev_b32 v70, 16, v83
    v_and_b32 v71, 0xffff0000, v83
    v_lshlrev_b32 v72, 16, v84
    v_and_b32 v73, 0xffff0000, v84
    v_lshlrev_b32 v74, 16, v85
    v_and_b32 v75, 0xffff0000, v85
    v_lshlrev_b32 v76, 16, v86
    v_and_b32 v77, 0xffff0000, v86
    v_lshlrev_b32 v78, 16, v87
    v_and_b32 v79, 0xffff0000, v87
    v_mul_f32 v64, 0xbfb8aa3b, v64
    v_mul_f32 v65, 0xbfb8aa3b, v65
    v_mul_f32 v66, 0xbfb8aa3b, v66
    v_mul_f32 v67, 0xbfb8aa3b, v67
    v_mul_f32 v68, 0xbfb8aa3b, v68
    v_mul_f32 v69, 0xbfb8aa3b, v69
    v_mul_f32 v70, 0xbfb8aa3b, v70
    v_mul_f32 v71, 0xbfb8aa3b, v71
    v_mul_f32 v72, 0xbfb8aa3b, v72
    v_mul_f32 v73, 0xbfb8aa3b, v73
    v_mul_f32 v74, 0xbfb8aa3b, v74
    v_mul_f32 v75, 0xbfb8aa3b, v75
    v_mul_f32 v76, 0xbfb8aa3b, v76
    v_mul_f32 v77, 0xbfb8aa3b, v77
    v_mul_f32 v78, 0xbfb8aa3b, v78
    v_mul_f32 v79, 0xbfb8aa3b, v79
    v_exp_f32 v64, v64
    v_exp_f32 v65, v65
    v_exp_f32 v66, v66
    v_exp_f32 v67, v67
    v_exp_f32 v68, v68
    v_exp_f32 v69, v69
    v_exp_f32 v70, v70
    v_exp_f32 v71, v71
    v_exp_f32 v72, v72
    v_exp_f32 v73, v73
    v_exp_f32 v74, v74
    v_exp_f32 v75, v75
    v_exp_f32 v76, v76
    v_exp_f32 v77, v77
    v_exp_f32 v78, v78
    v_exp_f32 v79, v79
    v_add_f32 v64, 1.0, v64
    v_add_f32 v65, 1.0, v65
    v_add_f32 v66, 1.0, v66
    v_add_f32 v67, 1.0, v67
    v_add_f32 v68, 1.0, v68
    v_add_f32 v69, 1.0, v69
    v_add_f32 v70, 1.0, v70
    v_add_f32 v71, 1.0, v71
    v_add_f32 v72, 1.0, v72
    v_add_f32 v73, 1.0, v73
    v_add_f32 v74, 1.0, v74
    v_add_f32 v75, 1.0, v75
    v_add_f32 v76, 1.0, v76
    v_add_f32 v77, 1.0, v77
    v_add_f32 v78, 1.0, v78
    v_add_f32 v79, 1.0, v79
    v_rcp_f32 v64, v64
    v_rcp_f32 v65, v65
    v_rcp_f32 v66, v66
    v_rcp_f32 v67, v67
    v_rcp_f32 v68, v68
    v_rcp_f32 v69, v69
    v_rcp_f32 v70, v70
    v_rcp_f32 v71, v71
    v_rcp_f32 v72, v72
    v_rcp_f32 v73, v73
    v_rcp_f32 v74, v74
    v_rcp_f32 v75, v75
    v_rcp_f32 v76, v76
    v_rcp_f32 v77, v77
    v_rcp_f32 v78, v78
    v_rcp_f32 v79, v79
    v_cvt_pk_bf16_f32 v80, v8, v9
    v_cvt_pk_bf16_f32 v81, v10, v11
    v_cvt_pk_bf16_f32 v82, v12, v13
    v_cvt_pk_bf16_f32 v83, v14, v15
    v_cvt_pk_bf16_f32 v84, v16, v17
    v_cvt_pk_bf16_f32 v85, v18, v19
    v_cvt_pk_bf16_f32 v86, v20, v21
    v_cvt_pk_bf16_f32 v87, v22, v23
    v_lshlrev_b32 v24, 16, v80
    v_and_b32 v25, 0xffff0000, v80
    v_lshlrev_b32 v26, 16, v81
    v_and_b32 v27, 0xffff0000, v81
    v_lshlrev_b32 v28, 16, v82
    v_and_b32 v29, 0xffff0000, v82
    v_lshlrev_b32 v30, 16, v83
    v_and_b32 v31, 0xffff0000, v83
    v_lshlrev_b32 v32, 16, v84
    v_and_b32 v33, 0xffff0000, v84
    v_lshlrev_b32 v34, 16, v85
    v_and_b32 v35, 0xffff0000, v85
    v_lshlrev_b32 v36, 16, v86
    v_and_b32 v37, 0xffff0000, v86
    v_lshlrev_b32 v38, 16, v87
    v_and_b32 v39, 0xffff0000, v87
    v_mul_f32 v64, v64, v24
    v_mul_f32 v65, v65, v25
    v_mul_f32 v66, v66, v26
    v_mul_f32 v67, v67, v27
    v_mul_f32 v68, v68, v28
    v_mul_f32 v69, v69, v29
    v_mul_f32 v70, v70, v30
    v_mul_f32 v71, v71, v31
    v_mul_f32 v72, v72, v32
    v_mul_f32 v73, v73, v33
    v_mul_f32 v74, v74, v34
    v_mul_f32 v75, v75, v35
    v_mul_f32 v76, v76, v36
    v_mul_f32 v77, v77, v37
    v_mul_f32 v78, v78, v38
    v_mul_f32 v79, v79, v39
    v_cvt_pk_bf16_f32 v248, v64, v65
    v_cvt_pk_bf16_f32 v249, v66, v67
    v_cvt_pk_bf16_f32 v250, v68, v69
    v_cvt_pk_bf16_f32 v251, v70, v71
    v_cvt_pk_bf16_f32 v252, v72, v73
    v_cvt_pk_bf16_f32 v253, v74, v75
    v_cvt_pk_bf16_f32 v254, v76, v77
    v_cvt_pk_bf16_f32 v255, v78, v79
    ds_write_b128 v59, v[240:243] offset:160
    ds_write_b128 v59, v[244:247] offset:176
    ds_write_b128 v58, v[248:251]
    ds_write_b128 v58, v[252:255] offset:16
    s_waitcnt lgkmcnt(0)
    ds_read_b128 v[192:195], v59 offset:0
    ds_read_b128 v[196:199], v59 offset:16
    ds_read_b128 v[200:203], v59 offset:80
    ds_read_b128 v[204:207], v59 offset:96
    ds_read_b128 v[208:211], v59 offset:160
    ds_read_b128 v[212:215], v59 offset:176
    ds_read_b128 v[216:219], v59 offset:240
    ds_read_b128 v[220:223], v59 offset:256
    ds_read_b128 v[240:243], v59 offset:320
    ds_read_b128 v[244:247], v59 offset:336
    s_waitcnt lgkmcnt(9)
    v_lshlrev_b32 v8, 16, v192
    v_and_b32 v9, 0xffff0000, v192
    v_lshlrev_b32 v10, 16, v193
    v_and_b32 v11, 0xffff0000, v193
    v_lshlrev_b32 v12, 16, v194
    v_and_b32 v13, 0xffff0000, v194
    v_lshlrev_b32 v14, 16, v195
    v_and_b32 v15, 0xffff0000, v195
    s_waitcnt lgkmcnt(8)
    v_lshlrev_b32 v16, 16, v196
    v_and_b32 v17, 0xffff0000, v196
    v_lshlrev_b32 v18, 16, v197
    v_and_b32 v19, 0xffff0000, v197
    v_lshlrev_b32 v20, 16, v198
    v_and_b32 v21, 0xffff0000, v198
    v_lshlrev_b32 v22, 16, v199
    v_and_b32 v23, 0xffff0000, v199
    v_lshlrev_b32 v24, 16, v88
    v_and_b32 v25, 0xffff0000, v88
    v_lshlrev_b32 v26, 16, v89
    v_and_b32 v27, 0xffff0000, v89
    v_lshlrev_b32 v28, 16, v90
    v_and_b32 v29, 0xffff0000, v90
    v_lshlrev_b32 v30, 16, v91
    v_and_b32 v31, 0xffff0000, v91
    v_lshlrev_b32 v32, 16, v92
    v_and_b32 v33, 0xffff0000, v92
    v_lshlrev_b32 v34, 16, v93
    v_and_b32 v35, 0xffff0000, v93
    v_lshlrev_b32 v36, 16, v94
    v_and_b32 v37, 0xffff0000, v94
    v_lshlrev_b32 v38, 16, v95
    v_and_b32 v39, 0xffff0000, v95
    v_mul_f32 v64, v8, v24
    v_mul_f32 v65, v9, v25
    v_mul_f32 v66, v10, v26
    v_mul_f32 v67, v11, v27
    v_mul_f32 v68, v12, v28
    v_mul_f32 v69, v13, v29
    v_mul_f32 v70, v14, v30
    v_mul_f32 v71, v15, v31
    v_mul_f32 v72, v16, v32
    v_mul_f32 v73, v17, v33
    v_mul_f32 v74, v18, v34
    v_mul_f32 v75, v19, v35
    v_mul_f32 v76, v20, v36
    v_mul_f32 v77, v21, v37
    v_mul_f32 v78, v22, v38
    v_mul_f32 v79, v23, v39
    s_waitcnt lgkmcnt(7)
    v_lshlrev_b32 v8, 16, v200
    v_and_b32 v9, 0xffff0000, v200
    v_lshlrev_b32 v10, 16, v201
    v_and_b32 v11, 0xffff0000, v201
    v_lshlrev_b32 v12, 16, v202
    v_and_b32 v13, 0xffff0000, v202
    v_lshlrev_b32 v14, 16, v203
    v_and_b32 v15, 0xffff0000, v203
    s_waitcnt lgkmcnt(6)
    v_lshlrev_b32 v16, 16, v204
    v_and_b32 v17, 0xffff0000, v204
    v_lshlrev_b32 v18, 16, v205
    v_and_b32 v19, 0xffff0000, v205
    v_lshlrev_b32 v20, 16, v206
    v_and_b32 v21, 0xffff0000, v206
    v_lshlrev_b32 v22, 16, v207
    v_and_b32 v23, 0xffff0000, v207
    v_lshlrev_b32 v24, 16, v96
    v_and_b32 v25, 0xffff0000, v96
    v_lshlrev_b32 v26, 16, v97
    v_and_b32 v27, 0xffff0000, v97
    v_lshlrev_b32 v28, 16, v98
    v_and_b32 v29, 0xffff0000, v98
    v_lshlrev_b32 v30, 16, v99
    v_and_b32 v31, 0xffff0000, v99
    v_lshlrev_b32 v32, 16, v100
    v_and_b32 v33, 0xffff0000, v100
    v_lshlrev_b32 v34, 16, v101
    v_and_b32 v35, 0xffff0000, v101
    v_lshlrev_b32 v36, 16, v102
    v_and_b32 v37, 0xffff0000, v102
    v_lshlrev_b32 v38, 16, v103
    v_and_b32 v39, 0xffff0000, v103
    v_fma_f32 v64, v8, v24, v64
    v_fma_f32 v65, v9, v25, v65
    v_fma_f32 v66, v10, v26, v66
    v_fma_f32 v67, v11, v27, v67
    v_fma_f32 v68, v12, v28, v68
    v_fma_f32 v69, v13, v29, v69
    v_fma_f32 v70, v14, v30, v70
    v_fma_f32 v71, v15, v31, v71
    v_fma_f32 v72, v16, v32, v72
    v_fma_f32 v73, v17, v33, v73
    v_fma_f32 v74, v18, v34, v74
    v_fma_f32 v75, v19, v35, v75
    v_fma_f32 v76, v20, v36, v76
    v_fma_f32 v77, v21, v37, v77
    v_fma_f32 v78, v22, v38, v78
    v_fma_f32 v79, v23, v39, v79
    s_waitcnt lgkmcnt(5)
    v_lshlrev_b32 v8, 16, v208
    v_and_b32 v9, 0xffff0000, v208
    v_lshlrev_b32 v10, 16, v209
    v_and_b32 v11, 0xffff0000, v209
    v_lshlrev_b32 v12, 16, v210
    v_and_b32 v13, 0xffff0000, v210
    v_lshlrev_b32 v14, 16, v211
    v_and_b32 v15, 0xffff0000, v211
    s_waitcnt lgkmcnt(4)
    v_lshlrev_b32 v16, 16, v212
    v_and_b32 v17, 0xffff0000, v212
    v_lshlrev_b32 v18, 16, v213
    v_and_b32 v19, 0xffff0000, v213
    v_lshlrev_b32 v20, 16, v214
    v_and_b32 v21, 0xffff0000, v214
    v_lshlrev_b32 v22, 16, v215
    v_and_b32 v23, 0xffff0000, v215
    v_lshlrev_b32 v24, 16, v104
    v_and_b32 v25, 0xffff0000, v104
    v_lshlrev_b32 v26, 16, v105
    v_and_b32 v27, 0xffff0000, v105
    v_lshlrev_b32 v28, 16, v106
    v_and_b32 v29, 0xffff0000, v106
    v_lshlrev_b32 v30, 16, v107
    v_and_b32 v31, 0xffff0000, v107
    v_lshlrev_b32 v32, 16, v108
    v_and_b32 v33, 0xffff0000, v108
    v_lshlrev_b32 v34, 16, v109
    v_and_b32 v35, 0xffff0000, v109
    v_lshlrev_b32 v36, 16, v110
    v_and_b32 v37, 0xffff0000, v110
    v_lshlrev_b32 v38, 16, v111
    v_and_b32 v39, 0xffff0000, v111
    v_fma_f32 v64, v8, v24, v64
    v_fma_f32 v65, v9, v25, v65
    v_fma_f32 v66, v10, v26, v66
    v_fma_f32 v67, v11, v27, v67
    v_fma_f32 v68, v12, v28, v68
    v_fma_f32 v69, v13, v29, v69
    v_fma_f32 v70, v14, v30, v70
    v_fma_f32 v71, v15, v31, v71
    v_fma_f32 v72, v16, v32, v72
    v_fma_f32 v73, v17, v33, v73
    v_fma_f32 v74, v18, v34, v74
    v_fma_f32 v75, v19, v35, v75
    v_fma_f32 v76, v20, v36, v76
    v_fma_f32 v77, v21, v37, v77
    v_fma_f32 v78, v22, v38, v78
    v_fma_f32 v79, v23, v39, v79
    s_waitcnt lgkmcnt(3)
    v_lshlrev_b32 v8, 16, v216
    v_and_b32 v9, 0xffff0000, v216
    v_lshlrev_b32 v10, 16, v217
    v_and_b32 v11, 0xffff0000, v217
    v_lshlrev_b32 v12, 16, v218
    v_and_b32 v13, 0xffff0000, v218
    v_lshlrev_b32 v14, 16, v219
    v_and_b32 v15, 0xffff0000, v219
    s_waitcnt lgkmcnt(2)
    v_lshlrev_b32 v16, 16, v220
    v_and_b32 v17, 0xffff0000, v220
    v_lshlrev_b32 v18, 16, v221
    v_and_b32 v19, 0xffff0000, v221
    v_lshlrev_b32 v20, 16, v222
    v_and_b32 v21, 0xffff0000, v222
    v_lshlrev_b32 v22, 16, v223
    v_and_b32 v23, 0xffff0000, v223
    v_lshlrev_b32 v24, 16, v112
    v_and_b32 v25, 0xffff0000, v112
    v_lshlrev_b32 v26, 16, v113
    v_and_b32 v27, 0xffff0000, v113
    v_lshlrev_b32 v28, 16, v114
    v_and_b32 v29, 0xffff0000, v114
    v_lshlrev_b32 v30, 16, v115
    v_and_b32 v31, 0xffff0000, v115
    v_lshlrev_b32 v32, 16, v116
    v_and_b32 v33, 0xffff0000, v116
    v_lshlrev_b32 v34, 16, v117
    v_and_b32 v35, 0xffff0000, v117
    v_lshlrev_b32 v36, 16, v118
    v_and_b32 v37, 0xffff0000, v118
    v_lshlrev_b32 v38, 16, v119
    v_and_b32 v39, 0xffff0000, v119
    v_fma_f32 v64, v8, v24, v64
    v_fma_f32 v65, v9, v25, v65
    v_fma_f32 v66, v10, v26, v66
    v_fma_f32 v67, v11, v27, v67
    v_fma_f32 v68, v12, v28, v68
    v_fma_f32 v69, v13, v29, v69
    v_fma_f32 v70, v14, v30, v70
    v_fma_f32 v71, v15, v31, v71
    v_fma_f32 v72, v16, v32, v72
    v_fma_f32 v73, v17, v33, v73
    v_fma_f32 v74, v18, v34, v74
    v_fma_f32 v75, v19, v35, v75
    v_fma_f32 v76, v20, v36, v76
    v_fma_f32 v77, v21, v37, v77
    v_fma_f32 v78, v22, v38, v78
    v_fma_f32 v79, v23, v39, v79
    s_waitcnt lgkmcnt(1)
    v_lshlrev_b32 v8, 16, v240
    v_and_b32 v9, 0xffff0000, v240
    v_lshlrev_b32 v10, 16, v241
    v_and_b32 v11, 0xffff0000, v241
    v_lshlrev_b32 v12, 16, v242
    v_and_b32 v13, 0xffff0000, v242
    v_lshlrev_b32 v14, 16, v243
    v_and_b32 v15, 0xffff0000, v243
    s_waitcnt lgkmcnt(0)
    v_lshlrev_b32 v16, 16, v244
    v_and_b32 v17, 0xffff0000, v244
    v_lshlrev_b32 v18, 16, v245
    v_and_b32 v19, 0xffff0000, v245
    v_lshlrev_b32 v20, 16, v246
    v_and_b32 v21, 0xffff0000, v246
    v_lshlrev_b32 v22, 16, v247
    v_and_b32 v23, 0xffff0000, v247
    v_lshlrev_b32 v24, 16, v120
    v_and_b32 v25, 0xffff0000, v120
    v_lshlrev_b32 v26, 16, v121
    v_and_b32 v27, 0xffff0000, v121
    v_lshlrev_b32 v28, 16, v122
    v_and_b32 v29, 0xffff0000, v122
    v_lshlrev_b32 v30, 16, v123
    v_and_b32 v31, 0xffff0000, v123
    v_lshlrev_b32 v32, 16, v124
    v_and_b32 v33, 0xffff0000, v124
    v_lshlrev_b32 v34, 16, v125
    v_and_b32 v35, 0xffff0000, v125
    v_lshlrev_b32 v36, 16, v126
    v_and_b32 v37, 0xffff0000, v126
    v_lshlrev_b32 v38, 16, v127
    v_and_b32 v39, 0xffff0000, v127
    v_fma_f32 v64, v8, v24, v64
    v_fma_f32 v65, v9, v25, v65
    v_fma_f32 v66, v10, v26, v66
    v_fma_f32 v67, v11, v27, v67
    v_fma_f32 v68, v12, v28, v68
    v_fma_f32 v69, v13, v29, v69
    v_fma_f32 v70, v14, v30, v70
    v_fma_f32 v71, v15, v31, v71
    v_fma_f32 v72, v16, v32, v72
    v_fma_f32 v73, v17, v33, v73
    v_fma_f32 v74, v18, v34, v74
    v_fma_f32 v75, v19, v35, v75
    v_fma_f32 v76, v20, v36, v76
    v_fma_f32 v77, v21, v37, v77
    v_fma_f32 v78, v22, v38, v78
    v_fma_f32 v79, v23, v39, v79
    v_cvt_pk_bf16_f32 v40, v64, v65
    v_cvt_pk_bf16_f32 v41, v66, v67
    v_cvt_pk_bf16_f32 v42, v68, v69
    v_cvt_pk_bf16_f32 v43, v70, v71
    v_cvt_pk_bf16_f32 v44, v72, v73
    v_cvt_pk_bf16_f32 v45, v74, v75
    v_cvt_pk_bf16_f32 v46, v76, v77
    v_cvt_pk_bf16_f32 v47, v78, v79
    v_lshlrev_b32 v8, 16, v40
    v_and_b32 v9, 0xffff0000, v40
    v_lshlrev_b32 v10, 16, v41
    v_and_b32 v11, 0xffff0000, v41
    v_lshlrev_b32 v12, 16, v42
    v_and_b32 v13, 0xffff0000, v42
    v_lshlrev_b32 v14, 16, v43
    v_and_b32 v15, 0xffff0000, v43
    v_lshlrev_b32 v16, 16, v44
    v_and_b32 v17, 0xffff0000, v44
    v_lshlrev_b32 v18, 16, v45
    v_and_b32 v19, 0xffff0000, v45
    v_lshlrev_b32 v20, 16, v46
    v_and_b32 v21, 0xffff0000, v46
    v_lshlrev_b32 v22, 16, v47
    v_and_b32 v23, 0xffff0000, v47
    v_mul_f32 v24, 0xbfb8aa3b, v8
    v_mul_f32 v25, 0xbfb8aa3b, v9
    v_mul_f32 v26, 0xbfb8aa3b, v10
    v_mul_f32 v27, 0xbfb8aa3b, v11
    v_mul_f32 v28, 0xbfb8aa3b, v12
    v_mul_f32 v29, 0xbfb8aa3b, v13
    v_mul_f32 v30, 0xbfb8aa3b, v14
    v_mul_f32 v31, 0xbfb8aa3b, v15
    v_mul_f32 v32, 0xbfb8aa3b, v16
    v_mul_f32 v33, 0xbfb8aa3b, v17
    v_mul_f32 v34, 0xbfb8aa3b, v18
    v_mul_f32 v35, 0xbfb8aa3b, v19
    v_mul_f32 v36, 0xbfb8aa3b, v20
    v_mul_f32 v37, 0xbfb8aa3b, v21
    v_mul_f32 v38, 0xbfb8aa3b, v22
    v_mul_f32 v39, 0xbfb8aa3b, v23
    v_exp_f32 v24, v24
    v_exp_f32 v25, v25
    v_exp_f32 v26, v26
    v_exp_f32 v27, v27
    v_exp_f32 v28, v28
    v_exp_f32 v29, v29
    v_exp_f32 v30, v30
    v_exp_f32 v31, v31
    v_exp_f32 v32, v32
    v_exp_f32 v33, v33
    v_exp_f32 v34, v34
    v_exp_f32 v35, v35
    v_exp_f32 v36, v36
    v_exp_f32 v37, v37
    v_exp_f32 v38, v38
    v_exp_f32 v39, v39
    v_add_f32 v24, 1.0, v24
    v_add_f32 v25, 1.0, v25
    v_add_f32 v26, 1.0, v26
    v_add_f32 v27, 1.0, v27
    v_add_f32 v28, 1.0, v28
    v_add_f32 v29, 1.0, v29
    v_add_f32 v30, 1.0, v30
    v_add_f32 v31, 1.0, v31
    v_add_f32 v32, 1.0, v32
    v_add_f32 v33, 1.0, v33
    v_add_f32 v34, 1.0, v34
    v_add_f32 v35, 1.0, v35
    v_add_f32 v36, 1.0, v36
    v_add_f32 v37, 1.0, v37
    v_add_f32 v38, 1.0, v38
    v_add_f32 v39, 1.0, v39
    v_rcp_f32 v24, v24
    v_rcp_f32 v25, v25
    v_rcp_f32 v26, v26
    v_rcp_f32 v27, v27
    v_rcp_f32 v28, v28
    v_rcp_f32 v29, v29
    v_rcp_f32 v30, v30
    v_rcp_f32 v31, v31
    v_rcp_f32 v32, v32
    v_rcp_f32 v33, v33
    v_rcp_f32 v34, v34
    v_rcp_f32 v35, v35
    v_rcp_f32 v36, v36
    v_rcp_f32 v37, v37
    v_rcp_f32 v38, v38
    v_rcp_f32 v39, v39
    v_mul_f32 v8, v8, v24
    v_mul_f32 v9, v9, v25
    v_mul_f32 v10, v10, v26
    v_mul_f32 v11, v11, v27
    v_mul_f32 v12, v12, v28
    v_mul_f32 v13, v13, v29
    v_mul_f32 v14, v14, v30
    v_mul_f32 v15, v15, v31
    v_mul_f32 v16, v16, v32
    v_mul_f32 v17, v17, v33
    v_mul_f32 v18, v18, v34
    v_mul_f32 v19, v19, v35
    v_mul_f32 v20, v20, v36
    v_mul_f32 v21, v21, v37
    v_mul_f32 v22, v22, v38
    v_mul_f32 v23, v23, v39
    v_cvt_pk_bf16_f32 v240, v8, v9
    v_cvt_pk_bf16_f32 v241, v10, v11
    v_cvt_pk_bf16_f32 v242, v12, v13
    v_cvt_pk_bf16_f32 v243, v14, v15
    v_cvt_pk_bf16_f32 v244, v16, v17
    v_cvt_pk_bf16_f32 v245, v18, v19
    v_cvt_pk_bf16_f32 v246, v20, v21
    v_cvt_pk_bf16_f32 v247, v22, v23
    ds_write_b128 v3, v[240:243]
    ds_write_b128 v3, v[244:247] offset:1024
    s_waitcnt lgkmcnt(0)
    s_barrier
    ds_read_b128 v[64:67], v2 offset:0
    ds_read_b128 v[68:71], v2 offset:1024
    ds_read_b128 v[72:75], v2 offset:2048
    ds_read_b128 v[76:79], v2 offset:3072
    ds_read_b128 v[80:83], v2 offset:4096
    ds_read_b128 v[84:87], v2 offset:5120
    ds_read_b128 v[88:91], v2 offset:6144
    ds_read_b128 v[92:95], v2 offset:7168
    ds_read_b128 v[96:99], v2 offset:8192
    ds_read_b128 v[100:103], v2 offset:9216
    ds_read_b128 v[104:107], v2 offset:10240
    ds_read_b128 v[108:111], v2 offset:11264
    ds_read_b128 v[112:115], v2 offset:12288
    ds_read_b128 v[116:119], v2 offset:13312
    ds_read_b128 v[120:123], v2 offset:14336
    ds_read_b128 v[124:127], v2 offset:15360
    s_waitcnt vmcnt(15) lgkmcnt(15)
    v_mfma_f32_32x32x16_bf16 v[192:207], v[128:131], v[64:67], 0
    buffer_load_dwordx4 v[128:131], v1, s[12:15], s24 offen offset:0
    s_waitcnt vmcnt(15) lgkmcnt(14)
    v_mfma_f32_32x32x16_bf16 v[192:207], v[132:135], v[68:71], v[192:207]
    buffer_load_dwordx4 v[132:135], v1, s[12:15], s24 offen offset:1024
    s_waitcnt vmcnt(15) lgkmcnt(13)
    v_mfma_f32_32x32x16_bf16 v[192:207], v[136:139], v[72:75], v[192:207]
    buffer_load_dwordx4 v[136:139], v1, s[12:15], s24 offen offset:2048
    s_waitcnt vmcnt(15) lgkmcnt(12)
    v_mfma_f32_32x32x16_bf16 v[192:207], v[140:143], v[76:79], v[192:207]
    buffer_load_dwordx4 v[140:143], v1, s[12:15], s24 offen offset:3072
    s_add_u32 s24, s24, 4096
    s_waitcnt vmcnt(15) lgkmcnt(11)
    v_mfma_f32_32x32x16_bf16 v[192:207], v[144:147], v[80:83], v[192:207]
    buffer_load_dwordx4 v[144:147], v1, s[12:15], s24 offen offset:0
    s_waitcnt vmcnt(15) lgkmcnt(10)
    v_mfma_f32_32x32x16_bf16 v[192:207], v[148:151], v[84:87], v[192:207]
    buffer_load_dwordx4 v[148:151], v1, s[12:15], s24 offen offset:1024
    s_waitcnt vmcnt(15) lgkmcnt(9)
    v_mfma_f32_32x32x16_bf16 v[192:207], v[152:155], v[88:91], v[192:207]
    buffer_load_dwordx4 v[152:155], v1, s[12:15], s24 offen offset:2048
    s_waitcnt vmcnt(15) lgkmcnt(8)
    v_mfma_f32_32x32x16_bf16 v[192:207], v[156:159], v[92:95], v[192:207]
    buffer_load_dwordx4 v[156:159], v1, s[12:15], s24 offen offset:3072
    s_add_u32 s24, s24, 4096
    s_waitcnt vmcnt(15) lgkmcnt(7)
    v_mfma_f32_32x32x16_bf16 v[192:207], v[160:163], v[96:99], v[192:207]
    buffer_load_dwordx4 v[160:163], v1, s[12:15], s24 offen offset:0
    s_waitcnt vmcnt(15) lgkmcnt(6)
    v_mfma_f32_32x32x16_bf16 v[192:207], v[164:167], v[100:103], v[192:207]
    buffer_load_dwordx4 v[164:167], v1, s[12:15], s24 offen offset:1024
    s_waitcnt vmcnt(15) lgkmcnt(5)
    v_mfma_f32_32x32x16_bf16 v[192:207], v[168:171], v[104:107], v[192:207]
    buffer_load_dwordx4 v[168:171], v1, s[12:15], s24 offen offset:2048
    s_waitcnt vmcnt(15) lgkmcnt(4)
    v_mfma_f32_32x32x16_bf16 v[192:207], v[172:175], v[108:111], v[192:207]
    buffer_load_dwordx4 v[172:175], v1, s[12:15], s24 offen offset:3072
    s_add_u32 s24, s24, 4096
    s_waitcnt vmcnt(15) lgkmcnt(3)
    v_mfma_f32_32x32x16_bf16 v[192:207], v[176:179], v[112:115], v[192:207]
    buffer_load_dwordx4 v[176:179], v1, s[12:15], s24 offen offset:0
    s_waitcnt vmcnt(15) lgkmcnt(2)
    v_mfma_f32_32x32x16_bf16 v[192:207], v[180:183], v[116:119], v[192:207]
    buffer_load_dwordx4 v[180:183], v1, s[12:15], s24 offen offset:1024
    s_waitcnt vmcnt(15) lgkmcnt(1)
    v_mfma_f32_32x32x16_bf16 v[192:207], v[184:187], v[120:123], v[192:207]
    buffer_load_dwordx4 v[184:187], v1, s[12:15], s24 offen offset:2048
    s_waitcnt vmcnt(15) lgkmcnt(0)
    v_mfma_f32_32x32x16_bf16 v[192:207], v[188:191], v[124:127], v[192:207]
    buffer_load_dwordx4 v[188:191], v1, s[12:15], s24 offen offset:3072
    s_add_u32 s24, s24, 4096
    s_nop 9
    v_add_f32 v8, v192, v224
    v_add_f32 v9, v193, v225
    v_add_f32 v10, v194, v226
    v_add_f32 v11, v195, v227
    v_add_f32 v12, v196, v228
    v_add_f32 v13, v197, v229
    v_add_f32 v14, v198, v230
    v_add_f32 v15, v199, v231
    v_add_f32 v16, v200, v232
    v_add_f32 v17, v201, v233
    v_add_f32 v18, v202, v234
    v_add_f32 v19, v203, v235
    v_add_f32 v20, v204, v236
    v_add_f32 v21, v205, v237
    v_add_f32 v22, v206, v238
    v_add_f32 v23, v207, v239
    v_cvt_pk_bf16_f32 v240, v8, v9
    v_cvt_pk_bf16_f32 v241, v10, v11
    v_cvt_pk_bf16_f32 v242, v12, v13
    v_cvt_pk_bf16_f32 v243, v14, v15
    v_cvt_pk_bf16_f32 v244, v16, v17
    v_cvt_pk_bf16_f32 v245, v18, v19
    v_cvt_pk_bf16_f32 v246, v20, v21
    v_cvt_pk_bf16_f32 v247, v22, v23
    v_lshlrev_b32 v224, 16, v240
    v_and_b32 v225, 0xffff0000, v240
    v_lshlrev_b32 v226, 16, v241
    v_and_b32 v227, 0xffff0000, v241
    v_lshlrev_b32 v228, 16, v242
    v_and_b32 v229, 0xffff0000, v242
    v_lshlrev_b32 v230, 16, v243
    v_and_b32 v231, 0xffff0000, v243
    v_lshlrev_b32 v232, 16, v244
    v_and_b32 v233, 0xffff0000, v244
    v_lshlrev_b32 v234, 16, v245
    v_and_b32 v235, 0xffff0000, v245
    v_lshlrev_b32 v236, 16, v246
    v_and_b32 v237, 0xffff0000, v246
    v_lshlrev_b32 v238, 16, v247
    v_and_b32 v239, 0xffff0000, v247
    v_add_f32 v8, v224, v225
    v_add_f32 v9, v226, v227
    v_add_f32 v8, v8, v228
    v_add_f32 v9, v9, v229
    v_add_f32 v8, v8, v230
    v_add_f32 v9, v9, v231
    v_add_f32 v8, v8, v232
    v_add_f32 v9, v9, v233
    v_add_f32 v8, v8, v234
    v_add_f32 v9, v9, v235
    v_add_f32 v8, v8, v236
    v_add_f32 v9, v9, v237
    v_add_f32 v8, v8, v238
    v_add_f32 v9, v9, v239
    v_add_f32 v8, v8, v9
    v_mul_f32 v8, 0x3d800000, v8
    v_sub_f32 v10, v224, v8
    v_mul_f32 v14, v10, v10
    v_sub_f32 v11, v225, v8
    v_mul_f32 v15, v11, v11
    v_sub_f32 v12, v226, v8
    v_fma_f32 v14, v12, v12, v14
    v_sub_f32 v13, v227, v8
    v_fma_f32 v15, v13, v13, v15
    v_sub_f32 v10, v228, v8
    v_fma_f32 v14, v10, v10, v14
    v_sub_f32 v11, v229, v8
    v_fma_f32 v15, v11, v11, v15
    v_sub_f32 v12, v230, v8
    v_fma_f32 v14, v12, v12, v14
    v_sub_f32 v13, v231, v8
    v_fma_f32 v15, v13, v13, v15
    v_sub_f32 v10, v232, v8
    v_fma_f32 v14, v10, v10, v14
    v_sub_f32 v11, v233, v8
    v_fma_f32 v15, v11, v11, v15
    v_sub_f32 v12, v234, v8
    v_fma_f32 v14, v12, v12, v14
    v_sub_f32 v13, v235, v8
    v_fma_f32 v15, v13, v13, v15
    v_sub_f32 v10, v236, v8
    v_fma_f32 v14, v10, v10, v14
    v_sub_f32 v11, v237, v8
    v_fma_f32 v15, v11, v11, v15
    v_sub_f32 v12, v238, v8
    v_fma_f32 v14, v12, v12, v14
    v_sub_f32 v13, v239, v8
    v_fma_f32 v15, v13, v13, v15
    v_add_f32 v9, v14, v15
    ds_write_b64 v5, v[8:9] offset:0
    s_waitcnt lgkmcnt(0)
    s_barrier
    ds_read_b128 v[64:67], v6 offset:0
    ds_read_b128 v[68:71], v6 offset:16
    ds_read_b128 v[72:75], v6 offset:32
    ds_read_b128 v[76:79], v6 offset:48
    ds_read_b128 v[80:83], v6 offset:64
    ds_read_b128 v[84:87], v6 offset:80
    ds_read_b128 v[88:91], v6 offset:96
    ds_read_b128 v[92:95], v6 offset:112
    s_waitcnt lgkmcnt(7)
    v_add_f32 v8, v64, v66
    s_waitcnt lgkmcnt(6)
    v_add_f32 v9, v68, v70
    s_waitcnt lgkmcnt(5)
    v_add_f32 v8, v8, v72
    v_add_f32 v9, v9, v74
    s_waitcnt lgkmcnt(4)
    v_add_f32 v8, v8, v76
    v_add_f32 v9, v9, v78
    s_waitcnt lgkmcnt(3)
    v_add_f32 v8, v8, v80
    v_add_f32 v9, v9, v82
    s_waitcnt lgkmcnt(2)
    v_add_f32 v8, v8, v84
    v_add_f32 v9, v9, v86
    s_waitcnt lgkmcnt(1)
    v_add_f32 v8, v8, v88
    v_add_f32 v9, v9, v90
    s_waitcnt lgkmcnt(0)
    v_add_f32 v8, v8, v92
    v_add_f32 v9, v9, v94
    v_add_f32 v8, v8, v9
    v_mul_f32 v8, 0x3d800000, v8
    v_add_f32 v9, v65, v67
    v_add_f32 v10, v69, v71
    v_add_f32 v9, v9, v73
    v_add_f32 v10, v10, v75
    v_add_f32 v9, v9, v77
    v_add_f32 v10, v10, v79
    v_add_f32 v9, v9, v81
    v_add_f32 v10, v10, v83
    v_add_f32 v9, v9, v85
    v_add_f32 v10, v10, v87
    v_add_f32 v9, v9, v89
    v_add_f32 v10, v10, v91
    v_add_f32 v9, v9, v93
    v_add_f32 v10, v10, v95
    v_add_f32 v9, v9, v10
    v_sub_f32 v12, v64, v8
    v_mul_f32 v10, v12, v12
    v_sub_f32 v13, v66, v8
    v_mul_f32 v11, v13, v13
    v_sub_f32 v14, v68, v8
    v_fma_f32 v10, v14, v14, v10
    v_sub_f32 v15, v70, v8
    v_fma_f32 v11, v15, v15, v11
    v_sub_f32 v12, v72, v8
    v_fma_f32 v10, v12, v12, v10
    v_sub_f32 v13, v74, v8
    v_fma_f32 v11, v13, v13, v11
    v_sub_f32 v14, v76, v8
    v_fma_f32 v10, v14, v14, v10
    v_sub_f32 v15, v78, v8
    v_fma_f32 v11, v15, v15, v11
    v_sub_f32 v12, v80, v8
    v_fma_f32 v10, v12, v12, v10
    v_sub_f32 v13, v82, v8
    v_fma_f32 v11, v13, v13, v11
    v_sub_f32 v14, v84, v8
    v_fma_f32 v10, v14, v14, v10
    v_sub_f32 v15, v86, v8
    v_fma_f32 v11, v15, v15, v11
    v_sub_f32 v12, v88, v8
    v_fma_f32 v10, v12, v12, v10
    v_sub_f32 v13, v90, v8
    v_fma_f32 v11, v13, v13, v11
    v_sub_f32 v14, v92, v8
    v_fma_f32 v10, v14, v14, v10
    v_sub_f32 v15, v94, v8
    v_fma_f32 v11, v15, v15, v11
    v_add_f32 v10, v10, v11
    v_mov_b32 v11, 0x41800000
    v_fma_f32 v9, v10, v11, v9
    v_mul_f32 v9, 0x3b800000, v9
    v_cvt_pk_bf16_f32 v10, v8, v9
    v_lshlrev_b32 v8, 16, v10
    v_and_b32 v9, 0xffff0000, v10
    v_add_f32 v9, 0x3727c5ac, v9
    v_cvt_pk_bf16_f32 v9, v9, v9
    v_lshlrev_b32 v9, 16, v9
    v_sqrt_f32 v9, v9
    s_nop 0
    v_cvt_pk_bf16_f32 v9, v9, v9
    v_lshlrev_b32 v9, 16, v9
    v_rcp_f32 v9, v9
    v_sub_f32 v10, v224, v8
    v_sub_f32 v11, v225, v8
    v_sub_f32 v12, v226, v8
    v_sub_f32 v13, v227, v8
    v_sub_f32 v14, v228, v8
    v_sub_f32 v15, v229, v8
    v_sub_f32 v16, v230, v8
    v_sub_f32 v17, v231, v8
    v_sub_f32 v18, v232, v8
    v_sub_f32 v19, v233, v8
    v_sub_f32 v20, v234, v8
    v_sub_f32 v21, v235, v8
    v_sub_f32 v22, v236, v8
    v_sub_f32 v23, v237, v8
    v_sub_f32 v24, v238, v8
    v_sub_f32 v25, v239, v8
    v_mul_f32 v10, v10, v9
    v_mul_f32 v11, v11, v9
    v_mul_f32 v12, v12, v9
    v_mul_f32 v13, v13, v9
    v_mul_f32 v14, v14, v9
    v_mul_f32 v15, v15, v9
    v_mul_f32 v16, v16, v9
    v_mul_f32 v17, v17, v9
    v_mul_f32 v18, v18, v9
    v_mul_f32 v19, v19, v9
    v_mul_f32 v20, v20, v9
    v_mul_f32 v21, v21, v9
    v_mul_f32 v22, v22, v9
    v_mul_f32 v23, v23, v9
    v_mul_f32 v24, v24, v9
    v_mul_f32 v25, v25, v9
    v_cvt_pk_bf16_f32 v240, v10, v11
    v_cvt_pk_bf16_f32 v241, v12, v13
    v_cvt_pk_bf16_f32 v242, v14, v15
    v_cvt_pk_bf16_f32 v243, v16, v17
    v_cvt_pk_bf16_f32 v244, v18, v19
    v_cvt_pk_bf16_f32 v245, v20, v21
    v_cvt_pk_bf16_f32 v246, v22, v23
    v_cvt_pk_bf16_f32 v247, v24, v25
    ds_write_b128 v3, v[240:243]
    ds_write_b128 v3, v[244:247] offset:1024
    s_waitcnt lgkmcnt(0)
    s_barrier
    ds_read_b128 v[64:67], v2 offset:0
    ds_read_b128 v[68:71], v2 offset:1024
    ds_read_b128 v[72:75], v2 offset:2048
    ds_read_b128 v[76:79], v2 offset:3072
    ds_read_b128 v[80:83], v2 offset:4096
    ds_read_b128 v[84:87], v2 offset:5120
    ds_read_b128 v[88:91], v2 offset:6144
    ds_read_b128 v[92:95], v2 offset:7168
    ds_read_b128 v[96:99], v2 offset:8192
    ds_read_b128 v[100:103], v2 offset:9216
    ds_read_b128 v[104:107], v2 offset:10240
    ds_read_b128 v[108:111], v2 offset:11264
    ds_read_b128 v[112:115], v2 offset:12288
    ds_read_b128 v[116:119], v2 offset:13312
    ds_read_b128 v[120:123], v2 offset:14336
    ds_read_b128 v[124:127], v2 offset:15360
    s_waitcnt vmcnt(15) lgkmcnt(15)
    v_mfma_f32_32x32x16_bf16 v[192:207], v[128:131], v[64:67], 0
    buffer_load_dwordx4 v[128:131], v1, s[12:15], s24 offen offset:0
    s_waitcnt vmcnt(15) lgkmcnt(14)
    v_mfma_f32_32x32x16_bf16 v[192:207], v[132:135], v[68:71], v[192:207]
    buffer_load_dwordx4 v[132:135], v1, s[12:15], s24 offen offset:1024
    s_waitcnt vmcnt(15) lgkmcnt(13)
    v_mfma_f32_32x32x16_bf16 v[192:207], v[136:139], v[72:75], v[192:207]
    buffer_load_dwordx4 v[136:139], v1, s[12:15], s24 offen offset:2048
    s_waitcnt vmcnt(15) lgkmcnt(12)
    v_mfma_f32_32x32x16_bf16 v[192:207], v[140:143], v[76:79], v[192:207]
    buffer_load_dwordx4 v[140:143], v1, s[12:15], s24 offen offset:3072
    s_add_u32 s24, s24, 4096
    s_waitcnt vmcnt(15) lgkmcnt(11)
    v_mfma_f32_32x32x16_bf16 v[192:207], v[144:147], v[80:83], v[192:207]
    buffer_load_dwordx4 v[144:147], v1, s[12:15], s24 offen offset:0
    s_waitcnt vmcnt(15) lgkmcnt(10)
    v_mfma_f32_32x32x16_bf16 v[192:207], v[148:151], v[84:87], v[192:207]
    buffer_load_dwordx4 v[148:151], v1, s[12:15], s24 offen offset:1024
    s_waitcnt vmcnt(15) lgkmcnt(9)
    v_mfma_f32_32x32x16_bf16 v[192:207], v[152:155], v[88:91], v[192:207]
    buffer_load_dwordx4 v[152:155], v1, s[12:15], s24 offen offset:2048
    s_waitcnt vmcnt(15) lgkmcnt(8)
    v_mfma_f32_32x32x16_bf16 v[192:207], v[156:159], v[92:95], v[192:207]
    buffer_load_dwordx4 v[156:159], v1, s[12:15], s24 offen offset:3072
    s_add_u32 s24, s24, 4096
    s_waitcnt vmcnt(15) lgkmcnt(7)
    v_mfma_f32_32x32x16_bf16 v[192:207], v[160:163], v[96:99], v[192:207]
    buffer_load_dwordx4 v[160:163], v1, s[12:15], s24 offen offset:0
    s_waitcnt vmcnt(15) lgkmcnt(6)
    v_mfma_f32_32x32x16_bf16 v[192:207], v[164:167], v[100:103], v[192:207]
    buffer_load_dwordx4 v[164:167], v1, s[12:15], s24 offen offset:1024
    s_waitcnt vmcnt(15) lgkmcnt(5)
    v_mfma_f32_32x32x16_bf16 v[192:207], v[168:171], v[104:107], v[192:207]
    buffer_load_dwordx4 v[168:171], v1, s[12:15], s24 offen offset:2048
    s_waitcnt vmcnt(15) lgkmcnt(4)
    v_mfma_f32_32x32x16_bf16 v[192:207], v[172:175], v[108:111], v[192:207]
    buffer_load_dwordx4 v[172:175], v1, s[12:15], s24 offen offset:3072
    s_add_u32 s24, s24, 4096
    s_waitcnt vmcnt(15) lgkmcnt(3)
    v_mfma_f32_32x32x16_bf16 v[192:207], v[176:179], v[112:115], v[192:207]
    buffer_load_dwordx4 v[176:179], v1, s[12:15], s24 offen offset:0
    s_waitcnt vmcnt(15) lgkmcnt(2)
    v_mfma_f32_32x32x16_bf16 v[192:207], v[180:183], v[116:119], v[192:207]
    buffer_load_dwordx4 v[180:183], v1, s[12:15], s24 offen offset:1024
    s_waitcnt vmcnt(15) lgkmcnt(1)
    v_mfma_f32_32x32x16_bf16 v[192:207], v[184:187], v[120:123], v[192:207]
    buffer_load_dwordx4 v[184:187], v1, s[12:15], s24 offen offset:2048
    s_waitcnt vmcnt(15) lgkmcnt(0)
    v_mfma_f32_32x32x16_bf16 v[192:207], v[188:191], v[124:127], v[192:207]
    buffer_load_dwordx4 v[188:191], v1, s[12:15], s24 offen offset:3072
    s_add_u32 s24, s24, 4096
    s_nop 9
    v_cvt_pk_bf16_f32 v40, v192, v193
    v_cvt_pk_bf16_f32 v41, v194, v195
    v_cvt_pk_bf16_f32 v42, v196, v197
    v_cvt_pk_bf16_f32 v43, v198, v199
    v_cvt_pk_bf16_f32 v44, v200, v201
    v_cvt_pk_bf16_f32 v45, v202, v203
    v_cvt_pk_bf16_f32 v46, v204, v205
    v_cvt_pk_bf16_f32 v47, v206, v207
    v_lshlrev_b32 v8, 16, v40
    v_and_b32 v9, 0xffff0000, v40
    v_lshlrev_b32 v10, 16, v41
    v_and_b32 v11, 0xffff0000, v41
    v_lshlrev_b32 v12, 16, v42
    v_and_b32 v13, 0xffff0000, v42
    v_lshlrev_b32 v14, 16, v43
    v_and_b32 v15, 0xffff0000, v43
    v_lshlrev_b32 v16, 16, v44
    v_and_b32 v17, 0xffff0000, v44
    v_lshlrev_b32 v18, 16, v45
    v_and_b32 v19, 0xffff0000, v45
    v_lshlrev_b32 v20, 16, v46
    v_and_b32 v21, 0xffff0000, v46
    v_lshlrev_b32 v22, 16, v47
    v_and_b32 v23, 0xffff0000, v47
    v_mul_f32 v24, 0xbfb8aa3b, v8
    v_mul_f32 v25, 0xbfb8aa3b, v9
    v_mul_f32 v26, 0xbfb8aa3b, v10
    v_mul_f32 v27, 0xbfb8aa3b, v11
    v_mul_f32 v28, 0xbfb8aa3b, v12
    v_mul_f32 v29, 0xbfb8aa3b, v13
    v_mul_f32 v30, 0xbfb8aa3b, v14
    v_mul_f32 v31, 0xbfb8aa3b, v15
    v_mul_f32 v32, 0xbfb8aa3b, v16
    v_mul_f32 v33, 0xbfb8aa3b, v17
    v_mul_f32 v34, 0xbfb8aa3b, v18
    v_mul_f32 v35, 0xbfb8aa3b, v19
    v_mul_f32 v36, 0xbfb8aa3b, v20
    v_mul_f32 v37, 0xbfb8aa3b, v21
    v_mul_f32 v38, 0xbfb8aa3b, v22
    v_mul_f32 v39, 0xbfb8aa3b, v23
    v_exp_f32 v24, v24
    v_exp_f32 v25, v25
    v_exp_f32 v26, v26
    v_exp_f32 v27, v27
    v_exp_f32 v28, v28
    v_exp_f32 v29, v29
    v_exp_f32 v30, v30
    v_exp_f32 v31, v31
    v_exp_f32 v32, v32
    v_exp_f32 v33, v33
    v_exp_f32 v34, v34
    v_exp_f32 v35, v35
    v_exp_f32 v36, v36
    v_exp_f32 v37, v37
    v_exp_f32 v38, v38
    v_exp_f32 v39, v39
    v_add_f32 v24, 1.0, v24
    v_add_f32 v25, 1.0, v25
    v_add_f32 v26, 1.0, v26
    v_add_f32 v27, 1.0, v27
    v_add_f32 v28, 1.0, v28
    v_add_f32 v29, 1.0, v29
    v_add_f32 v30, 1.0, v30
    v_add_f32 v31, 1.0, v31
    v_add_f32 v32, 1.0, v32
    v_add_f32 v33, 1.0, v33
    v_add_f32 v34, 1.0, v34
    v_add_f32 v35, 1.0, v35
    v_add_f32 v36, 1.0, v36
    v_add_f32 v37, 1.0, v37
    v_add_f32 v38, 1.0, v38
    v_add_f32 v39, 1.0, v39
    v_rcp_f32 v24, v24
    v_rcp_f32 v25, v25
    v_rcp_f32 v26, v26
    v_rcp_f32 v27, v27
    v_rcp_f32 v28, v28
    v_rcp_f32 v29, v29
    v_rcp_f32 v30, v30
    v_rcp_f32 v31, v31
    v_rcp_f32 v32, v32
    v_rcp_f32 v33, v33
    v_rcp_f32 v34, v34
    v_rcp_f32 v35, v35
    v_rcp_f32 v36, v36
    v_rcp_f32 v37, v37
    v_rcp_f32 v38, v38
    v_rcp_f32 v39, v39
    v_mul_f32 v8, v8, v24
    v_mul_f32 v9, v9, v25
    v_mul_f32 v10, v10, v26
    v_mul_f32 v11, v11, v27
    v_mul_f32 v12, v12, v28
    v_mul_f32 v13, v13, v29
    v_mul_f32 v14, v14, v30
    v_mul_f32 v15, v15, v31
    v_mul_f32 v16, v16, v32
    v_mul_f32 v17, v17, v33
    v_mul_f32 v18, v18, v34
    v_mul_f32 v19, v19, v35
    v_mul_f32 v20, v20, v36
    v_mul_f32 v21, v21, v37
    v_mul_f32 v22, v22, v38
    v_mul_f32 v23, v23, v39
    v_cvt_pk_bf16_f32 v240, v8, v9
    v_cvt_pk_bf16_f32 v241, v10, v11
    v_cvt_pk_bf16_f32 v242, v12, v13
    v_cvt_pk_bf16_f32 v243, v14, v15
    v_cvt_pk_bf16_f32 v244, v16, v17
    v_cvt_pk_bf16_f32 v245, v18, v19
    v_cvt_pk_bf16_f32 v246, v20, v21
    v_cvt_pk_bf16_f32 v247, v22, v23
    ds_write_b128 v4, v[240:243] offset:0
    ds_write_b128 v4, v[244:247] offset:1024
    s_waitcnt vmcnt(15)
    v_mfma_f32_32x32x16_bf16 v[208:223], v[128:131], v[64:67], 0
    buffer_load_dwordx4 v[128:131], v1, s[12:15], s24 offen offset:0
    s_waitcnt vmcnt(15)
    v_mfma_f32_32x32x16_bf16 v[208:223], v[132:135], v[68:71], v[208:223]
    buffer_load_dwordx4 v[132:135], v1, s[12:15], s24 offen offset:1024
    s_waitcnt vmcnt(15)
    v_mfma_f32_32x32x16_bf16 v[208:223], v[136:139], v[72:75], v[208:223]
    buffer_load_dwordx4 v[136:139], v1, s[12:15], s24 offen offset:2048
    s_waitcnt vmcnt(15)
    v_mfma_f32_32x32x16_bf16 v[208:223], v[140:143], v[76:79], v[208:223]
    buffer_load_dwordx4 v[140:143], v1, s[12:15], s24 offen offset:3072
    s_add_u32 s24, s24, 4096
    s_waitcnt vmcnt(15)
    v_mfma_f32_32x32x16_bf16 v[208:223], v[144:147], v[80:83], v[208:223]
    buffer_load_dwordx4 v[144:147], v1, s[12:15], s24 offen offset:0
    s_waitcnt vmcnt(15)
    v_mfma_f32_32x32x16_bf16 v[208:223], v[148:151], v[84:87], v[208:223]
    buffer_load_dwordx4 v[148:151], v1, s[12:15], s24 offen offset:1024
    s_waitcnt vmcnt(15)
    v_mfma_f32_32x32x16_bf16 v[208:223], v[152:155], v[88:91], v[208:223]
    buffer_load_dwordx4 v[152:155], v1, s[12:15], s24 offen offset:2048
    s_waitcnt vmcnt(15)
    v_mfma_f32_32x32x16_bf16 v[208:223], v[156:159], v[92:95], v[208:223]
    buffer_load_dwordx4 v[156:159], v1, s[12:15], s24 offen offset:3072
    s_add_u32 s24, s24, 4096
    s_waitcnt vmcnt(15)
    v_mfma_f32_32x32x16_bf16 v[208:223], v[160:163], v[96:99], v[208:223]
    buffer_load_dwordx4 v[160:163], v1, s[12:15], s24 offen offset:0
    s_waitcnt vmcnt(15)
    v_mfma_f32_32x32x16_bf16 v[208:223], v[164:167], v[100:103], v[208:223]
    buffer_load_dwordx4 v[164:167], v1, s[12:15], s24 offen offset:1024
    s_waitcnt vmcnt(15)
    v_mfma_f32_32x32x16_bf16 v[208:223], v[168:171], v[104:107], v[208:223]
    buffer_load_dwordx4 v[168:171], v1, s[12:15], s24 offen offset:2048
    s_waitcnt vmcnt(15)
    v_mfma_f32_32x32x16_bf16 v[208:223], v[172:175], v[108:111], v[208:223]
    buffer_load_dwordx4 v[172:175], v1, s[12:15], s24 offen offset:3072
    s_add_u32 s24, s24, 4096
    s_waitcnt vmcnt(15)
    v_mfma_f32_32x32x16_bf16 v[208:223], v[176:179], v[112:115], v[208:223]
    buffer_load_dwordx4 v[176:179], v1, s[12:15], s24 offen offset:0
    s_waitcnt vmcnt(15)
    v_mfma_f32_32x32x16_bf16 v[208:223], v[180:183], v[116:119], v[208:223]
    buffer_load_dwordx4 v[180:183], v1, s[12:15], s24 offen offset:1024
    s_waitcnt vmcnt(15)
    v_mfma_f32_32x32x16_bf16 v[208:223], v[184:187], v[120:123], v[208:223]
    buffer_load_dwordx4 v[184:187], v1, s[12:15], s24 offen offset:2048
    s_waitcnt vmcnt(15)
    v_mfma_f32_32x32x16_bf16 v[208:223], v[188:191], v[124:127], v[208:223]
    buffer_load_dwordx4 v[188:191], v1, s[12:15], s24 offen offset:3072
    s_add_u32 s24, s24, 4096
    s_nop 9
    v_cvt_pk_bf16_f32 v40, v208, v209
    v_cvt_pk_bf16_f32 v41, v210, v211
    v_cvt_pk_bf16_f32 v42, v212, v213
    v_cvt_pk_bf16_f32 v43, v214, v215
    v_cvt_pk_bf16_f32 v44, v216, v217
    v_cvt_pk_bf16_f32 v45, v218, v219
    v_cvt_pk_bf16_f32 v46, v220, v221
    v_cvt_pk_bf16_f32 v47, v222, v223
    v_lshlrev_b32 v8, 16, v40
    v_and_b32 v9, 0xffff0000, v40
    v_lshlrev_b32 v10, 16, v41
    v_and_b32 v11, 0xffff0000, v41
    v_lshlrev_b32 v12, 16, v42
    v_and_b32 v13, 0xffff0000, v42
    v_lshlrev_b32 v14, 16, v43
    v_and_b32 v15, 0xffff0000, v43
    v_lshlrev_b32 v16, 16, v44
    v_and_b32 v17, 0xffff0000, v44
    v_lshlrev_b32 v18, 16, v45
    v_and_b32 v19, 0xffff0000, v45
    v_lshlrev_b32 v20, 16, v46
    v_and_b32 v21, 0xffff0000, v46
    v_lshlrev_b32 v22, 16, v47
    v_and_b32 v23, 0xffff0000, v47
    v_mul_f32 v24, 0xbfb8aa3b, v8
    v_mul_f32 v25, 0xbfb8aa3b, v9
    v_mul_f32 v26, 0xbfb8aa3b, v10
    v_mul_f32 v27, 0xbfb8aa3b, v11
    v_mul_f32 v28, 0xbfb8aa3b, v12
    v_mul_f32 v29, 0xbfb8aa3b, v13
    v_mul_f32 v30, 0xbfb8aa3b, v14
    v_mul_f32 v31, 0xbfb8aa3b, v15
    v_mul_f32 v32, 0xbfb8aa3b, v16
    v_mul_f32 v33, 0xbfb8aa3b, v17
    v_mul_f32 v34, 0xbfb8aa3b, v18
    v_mul_f32 v35, 0xbfb8aa3b, v19
    v_mul_f32 v36, 0xbfb8aa3b, v20
    v_mul_f32 v37, 0xbfb8aa3b, v21
    v_mul_f32 v38, 0xbfb8aa3b, v22
    v_mul_f32 v39, 0xbfb8aa3b, v23
    v_exp_f32 v24, v24
    v_exp_f32 v25, v25
    v_exp_f32 v26, v26
    v_exp_f32 v27, v27
    v_exp_f32 v28, v28
    v_exp_f32 v29, v29
    v_exp_f32 v30, v30
    v_exp_f32 v31, v31
    v_exp_f32 v32, v32
    v_exp_f32 v33, v33
    v_exp_f32 v34, v34
    v_exp_f32 v35, v35
    v_exp_f32 v36, v36
    v_exp_f32 v37, v37
    v_exp_f32 v38, v38
    v_exp_f32 v39, v39
    v_add_f32 v24, 1.0, v24
    v_add_f32 v25, 1.0, v25
    v_add_f32 v26, 1.0, v26
    v_add_f32 v27, 1.0, v27
    v_add_f32 v28, 1.0, v28
    v_add_f32 v29, 1.0, v29
    v_add_f32 v30, 1.0, v30
    v_add_f32 v31, 1.0, v31
    v_add_f32 v32, 1.0, v32
    v_add_f32 v33, 1.0, v33
    v_add_f32 v34, 1.0, v34
    v_add_f32 v35, 1.0, v35
    v_add_f32 v36, 1.0, v36
    v_add_f32 v37, 1.0, v37
    v_add_f32 v38, 1.0, v38
    v_add_f32 v39, 1.0, v39
    v_rcp_f32 v24, v24
    v_rcp_f32 v25, v25
    v_rcp_f32 v26, v26
    v_rcp_f32 v27, v27
    v_rcp_f32 v28, v28
    v_rcp_f32 v29, v29
    v_rcp_f32 v30, v30
    v_rcp_f32 v31, v31
    v_rcp_f32 v32, v32
    v_rcp_f32 v33, v33
    v_rcp_f32 v34, v34
    v_rcp_f32 v35, v35
    v_rcp_f32 v36, v36
    v_rcp_f32 v37, v37
    v_rcp_f32 v38, v38
    v_rcp_f32 v39, v39
    v_mul_f32 v8, v8, v24
    v_mul_f32 v9, v9, v25
    v_mul_f32 v10, v10, v26
    v_mul_f32 v11, v11, v27
    v_mul_f32 v12, v12, v28
    v_mul_f32 v13, v13, v29
    v_mul_f32 v14, v14, v30
    v_mul_f32 v15, v15, v31
    v_mul_f32 v16, v16, v32
    v_mul_f32 v17, v17, v33
    v_mul_f32 v18, v18, v34
    v_mul_f32 v19, v19, v35
    v_mul_f32 v20, v20, v36
    v_mul_f32 v21, v21, v37
    v_mul_f32 v22, v22, v38
    v_mul_f32 v23, v23, v39
    v_cvt_pk_bf16_f32 v240, v8, v9
    v_cvt_pk_bf16_f32 v241, v10, v11
    v_cvt_pk_bf16_f32 v242, v12, v13
    v_cvt_pk_bf16_f32 v243, v14, v15
    v_cvt_pk_bf16_f32 v244, v16, v17
    v_cvt_pk_bf16_f32 v245, v18, v19
    v_cvt_pk_bf16_f32 v246, v20, v21
    v_cvt_pk_bf16_f32 v247, v22, v23
    ds_write_b128 v4, v[240:243] offset:2048
    ds_write_b128 v4, v[244:247] offset:3072
    s_waitcnt vmcnt(15)
    v_mfma_f32_32x32x16_bf16 v[192:207], v[128:131], v[64:67], 0
    buffer_load_dwordx4 v[128:131], v1, s[12:15], s24 offen offset:0
    s_waitcnt vmcnt(15)
    v_mfma_f32_32x32x16_bf16 v[192:207], v[132:135], v[68:71], v[192:207]
    buffer_load_dwordx4 v[132:135], v1, s[12:15], s24 offen offset:1024
    s_waitcnt vmcnt(15)
    v_mfma_f32_32x32x16_bf16 v[192:207], v[136:139], v[72:75], v[192:207]
    buffer_load_dwordx4 v[136:139], v1, s[12:15], s24 offen offset:2048
    s_waitcnt vmcnt(15)
    v_mfma_f32_32x32x16_bf16 v[192:207], v[140:143], v[76:79], v[192:207]
    buffer_load_dwordx4 v[140:143], v1, s[12:15], s24 offen offset:3072
    s_add_u32 s24, s24, 4096
    s_waitcnt vmcnt(15)
    v_mfma_f32_32x32x16_bf16 v[192:207], v[144:147], v[80:83], v[192:207]
    buffer_load_dwordx4 v[144:147], v1, s[12:15], s24 offen offset:0
    s_waitcnt vmcnt(15)
    v_mfma_f32_32x32x16_bf16 v[192:207], v[148:151], v[84:87], v[192:207]
    buffer_load_dwordx4 v[148:151], v1, s[12:15], s24 offen offset:1024
    s_waitcnt vmcnt(15)
    v_mfma_f32_32x32x16_bf16 v[192:207], v[152:155], v[88:91], v[192:207]
    buffer_load_dwordx4 v[152:155], v1, s[12:15], s24 offen offset:2048
    s_waitcnt vmcnt(15)
    v_mfma_f32_32x32x16_bf16 v[192:207], v[156:159], v[92:95], v[192:207]
    buffer_load_dwordx4 v[156:159], v1, s[12:15], s24 offen offset:3072
    s_add_u32 s24, s24, 4096
    s_waitcnt vmcnt(15)
    v_mfma_f32_32x32x16_bf16 v[192:207], v[160:163], v[96:99], v[192:207]
    buffer_load_dwordx4 v[160:163], v1, s[12:15], s24 offen offset:0
    s_waitcnt vmcnt(15)
    v_mfma_f32_32x32x16_bf16 v[192:207], v[164:167], v[100:103], v[192:207]
    buffer_load_dwordx4 v[164:167], v1, s[12:15], s24 offen offset:1024
    s_waitcnt vmcnt(15)
    v_mfma_f32_32x32x16_bf16 v[192:207], v[168:171], v[104:107], v[192:207]
    buffer_load_dwordx4 v[168:171], v1, s[12:15], s24 offen offset:2048
    s_waitcnt vmcnt(15)
    v_mfma_f32_32x32x16_bf16 v[192:207], v[172:175], v[108:111], v[192:207]
    buffer_load_dwordx4 v[172:175], v1, s[12:15], s24 offen offset:3072
    s_add_u32 s24, s24, 4096
    s_waitcnt vmcnt(15)
    v_mfma_f32_32x32x16_bf16 v[192:207], v[176:179], v[112:115], v[192:207]
    buffer_load_dwordx4 v[176:179], v1, s[12:15], s24 offen offset:0
    s_waitcnt vmcnt(15)
    v_mfma_f32_32x32x16_bf16 v[192:207], v[180:183], v[116:119], v[192:207]
    buffer_load_dwordx4 v[180:183], v1, s[12:15], s24 offen offset:1024
    s_waitcnt vmcnt(15)
    v_mfma_f32_32x32x16_bf16 v[192:207], v[184:187], v[120:123], v[192:207]
    buffer_load_dwordx4 v[184:187], v1, s[12:15], s24 offen offset:2048
    s_waitcnt vmcnt(15)
    v_mfma_f32_32x32x16_bf16 v[192:207], v[188:191], v[124:127], v[192:207]
    buffer_load_dwordx4 v[188:191], v1, s[12:15], s24 offen offset:3072
    s_add_u32 s24, s24, 4096
    s_nop 9
    v_cvt_pk_bf16_f32 v40, v192, v193
    v_cvt_pk_bf16_f32 v41, v194, v195
    v_cvt_pk_bf16_f32 v42, v196, v197
    v_cvt_pk_bf16_f32 v43, v198, v199
    v_cvt_pk_bf16_f32 v44, v200, v201
    v_cvt_pk_bf16_f32 v45, v202, v203
    v_cvt_pk_bf16_f32 v46, v204, v205
    v_cvt_pk_bf16_f32 v47, v206, v207
    v_lshlrev_b32 v8, 16, v40
    v_and_b32 v9, 0xffff0000, v40
    v_lshlrev_b32 v10, 16, v41
    v_and_b32 v11, 0xffff0000, v41
    v_lshlrev_b32 v12, 16, v42
    v_and_b32 v13, 0xffff0000, v42
    v_lshlrev_b32 v14, 16, v43
    v_and_b32 v15, 0xffff0000, v43
    v_lshlrev_b32 v16, 16, v44
    v_and_b32 v17, 0xffff0000, v44
    v_lshlrev_b32 v18, 16, v45
    v_and_b32 v19, 0xffff0000, v45
    v_lshlrev_b32 v20, 16, v46
    v_and_b32 v21, 0xffff0000, v46
    v_lshlrev_b32 v22, 16, v47
    v_and_b32 v23, 0xffff0000, v47
    v_mul_f32 v24, 0xbfb8aa3b, v8
    v_mul_f32 v25, 0xbfb8aa3b, v9
    v_mul_f32 v26, 0xbfb8aa3b, v10
    v_mul_f32 v27, 0xbfb8aa3b, v11
    v_mul_f32 v28, 0xbfb8aa3b, v12
    v_mul_f32 v29, 0xbfb8aa3b, v13
    v_mul_f32 v30, 0xbfb8aa3b, v14
    v_mul_f32 v31, 0xbfb8aa3b, v15
    v_mul_f32 v32, 0xbfb8aa3b, v16
    v_mul_f32 v33, 0xbfb8aa3b, v17
    v_mul_f32 v34, 0xbfb8aa3b, v18
    v_mul_f32 v35, 0xbfb8aa3b, v19
    v_mul_f32 v36, 0xbfb8aa3b, v20
    v_mul_f32 v37, 0xbfb8aa3b, v21
    v_mul_f32 v38, 0xbfb8aa3b, v22
    v_mul_f32 v39, 0xbfb8aa3b, v23
    v_exp_f32 v24, v24
    v_exp_f32 v25, v25
    v_exp_f32 v26, v26
    v_exp_f32 v27, v27
    v_exp_f32 v28, v28
    v_exp_f32 v29, v29
    v_exp_f32 v30, v30
    v_exp_f32 v31, v31
    v_exp_f32 v32, v32
    v_exp_f32 v33, v33
    v_exp_f32 v34, v34
    v_exp_f32 v35, v35
    v_exp_f32 v36, v36
    v_exp_f32 v37, v37
    v_exp_f32 v38, v38
    v_exp_f32 v39, v39
    v_add_f32 v24, 1.0, v24
    v_add_f32 v25, 1.0, v25
    v_add_f32 v26, 1.0, v26
    v_add_f32 v27, 1.0, v27
    v_add_f32 v28, 1.0, v28
    v_add_f32 v29, 1.0, v29
    v_add_f32 v30, 1.0, v30
    v_add_f32 v31, 1.0, v31
    v_add_f32 v32, 1.0, v32
    v_add_f32 v33, 1.0, v33
    v_add_f32 v34, 1.0, v34
    v_add_f32 v35, 1.0, v35
    v_add_f32 v36, 1.0, v36
    v_add_f32 v37, 1.0, v37
    v_add_f32 v38, 1.0, v38
    v_add_f32 v39, 1.0, v39
    v_rcp_f32 v24, v24
    v_rcp_f32 v25, v25
    v_rcp_f32 v26, v26
    v_rcp_f32 v27, v27
    v_rcp_f32 v28, v28
    v_rcp_f32 v29, v29
    v_rcp_f32 v30, v30
    v_rcp_f32 v31, v31
    v_rcp_f32 v32, v32
    v_rcp_f32 v33, v33
    v_rcp_f32 v34, v34
    v_rcp_f32 v35, v35
    v_rcp_f32 v36, v36
    v_rcp_f32 v37, v37
    v_rcp_f32 v38, v38
    v_rcp_f32 v39, v39
    v_mul_f32 v8, v8, v24
    v_mul_f32 v9, v9, v25
    v_mul_f32 v10, v10, v26
    v_mul_f32 v11, v11, v27
    v_mul_f32 v12, v12, v28
    v_mul_f32 v13, v13, v29
    v_mul_f32 v14, v14, v30
    v_mul_f32 v15, v15, v31
    v_mul_f32 v16, v16, v32
    v_mul_f32 v17, v17, v33
    v_mul_f32 v18, v18, v34
    v_mul_f32 v19, v19, v35
    v_mul_f32 v20, v20, v36
    v_mul_f32 v21, v21, v37
    v_mul_f32 v22, v22, v38
    v_mul_f32 v23, v23, v39
    v_cvt_pk_bf16_f32 v240, v8, v9
    v_cvt_pk_bf16_f32 v241, v10, v11
    v_cvt_pk_bf16_f32 v242, v12, v13
    v_cvt_pk_bf16_f32 v243, v14, v15
    v_cvt_pk_bf16_f32 v244, v16, v17
    v_cvt_pk_bf16_f32 v245, v18, v19
    v_cvt_pk_bf16_f32 v246, v20, v21
    v_cvt_pk_bf16_f32 v247, v22, v23
    ds_write_b128 v4, v[240:243] offset:4096
    ds_write_b128 v4, v[244:247] offset:5120
    s_waitcnt vmcnt(15)
    v_mfma_f32_32x32x16_bf16 v[208:223], v[128:131], v[64:67], 0
    buffer_load_dwordx4 v[128:131], v1, s[12:15], s24 offen offset:0
    s_waitcnt vmcnt(15)
    v_mfma_f32_32x32x16_bf16 v[208:223], v[132:135], v[68:71], v[208:223]
    buffer_load_dwordx4 v[132:135], v1, s[12:15], s24 offen offset:1024
    s_waitcnt vmcnt(15)
    v_mfma_f32_32x32x16_bf16 v[208:223], v[136:139], v[72:75], v[208:223]
    buffer_load_dwordx4 v[136:139], v1, s[12:15], s24 offen offset:2048
    s_waitcnt vmcnt(15)
    v_mfma_f32_32x32x16_bf16 v[208:223], v[140:143], v[76:79], v[208:223]
    buffer_load_dwordx4 v[140:143], v1, s[12:15], s24 offen offset:3072
    s_add_u32 s24, s24, 4096
    s_waitcnt vmcnt(15)
    v_mfma_f32_32x32x16_bf16 v[208:223], v[144:147], v[80:83], v[208:223]
    buffer_load_dwordx4 v[144:147], v1, s[12:15], s24 offen offset:0
    s_waitcnt vmcnt(15)
    v_mfma_f32_32x32x16_bf16 v[208:223], v[148:151], v[84:87], v[208:223]
    buffer_load_dwordx4 v[148:151], v1, s[12:15], s24 offen offset:1024
    s_waitcnt vmcnt(15)
    v_mfma_f32_32x32x16_bf16 v[208:223], v[152:155], v[88:91], v[208:223]
    buffer_load_dwordx4 v[152:155], v1, s[12:15], s24 offen offset:2048
    s_waitcnt vmcnt(15)
    v_mfma_f32_32x32x16_bf16 v[208:223], v[156:159], v[92:95], v[208:223]
    buffer_load_dwordx4 v[156:159], v1, s[12:15], s24 offen offset:3072
    s_add_u32 s24, s24, 4096
    s_waitcnt vmcnt(15)
    v_mfma_f32_32x32x16_bf16 v[208:223], v[160:163], v[96:99], v[208:223]
    buffer_load_dwordx4 v[160:163], v1, s[12:15], s24 offen offset:0
    s_waitcnt vmcnt(15)
    v_mfma_f32_32x32x16_bf16 v[208:223], v[164:167], v[100:103], v[208:223]
    buffer_load_dwordx4 v[164:167], v1, s[12:15], s24 offen offset:1024
    s_waitcnt vmcnt(15)
    v_mfma_f32_32x32x16_bf16 v[208:223], v[168:171], v[104:107], v[208:223]
    buffer_load_dwordx4 v[168:171], v1, s[12:15], s24 offen offset:2048
    s_waitcnt vmcnt(15)
    v_mfma_f32_32x32x16_bf16 v[208:223], v[172:175], v[108:111], v[208:223]
    buffer_load_dwordx4 v[172:175], v1, s[12:15], s24 offen offset:3072
    s_add_u32 s24, s24, 4096
    s_waitcnt vmcnt(15)
    v_mfma_f32_32x32x16_bf16 v[208:223], v[176:179], v[112:115], v[208:223]
    buffer_load_dwordx4 v[176:179], v1, s[12:15], s24 offen offset:0
    s_waitcnt vmcnt(15)
    v_mfma_f32_32x32x16_bf16 v[208:223], v[180:183], v[116:119], v[208:223]
    buffer_load_dwordx4 v[180:183], v1, s[12:15], s24 offen offset:1024
    s_waitcnt vmcnt(15)
    v_mfma_f32_32x32x16_bf16 v[208:223], v[184:187], v[120:123], v[208:223]
    buffer_load_dwordx4 v[184:187], v1, s[12:15], s24 offen offset:2048
    s_waitcnt vmcnt(15)
    v_mfma_f32_32x32x16_bf16 v[208:223], v[188:191], v[124:127], v[208:223]
    buffer_load_dwordx4 v[188:191], v1, s[12:15], s24 offen offset:3072
    s_add_u32 s24, s24, 4096
    s_nop 9
    v_cvt_pk_bf16_f32 v40, v208, v209
    v_cvt_pk_bf16_f32 v41, v210, v211
    v_cvt_pk_bf16_f32 v42, v212, v213
    v_cvt_pk_bf16_f32 v43, v214, v215
    v_cvt_pk_bf16_f32 v44, v216, v217
    v_cvt_pk_bf16_f32 v45, v218, v219
    v_cvt_pk_bf16_f32 v46, v220, v221
    v_cvt_pk_bf16_f32 v47, v222, v223
    v_lshlrev_b32 v8, 16, v40
    v_and_b32 v9, 0xffff0000, v40
    v_lshlrev_b32 v10, 16, v41
    v_and_b32 v11, 0xffff0000, v41
    v_lshlrev_b32 v12, 16, v42
    v_and_b32 v13, 0xffff0000, v42
    v_lshlrev_b32 v14, 16, v43
    v_and_b32 v15, 0xffff0000, v43
    v_lshlrev_b32 v16, 16, v44
    v_and_b32 v17, 0xffff0000, v44
    v_lshlrev_b32 v18, 16, v45
    v_and_b32 v19, 0xffff0000, v45
    v_lshlrev_b32 v20, 16, v46
    v_and_b32 v21, 0xffff0000, v46
    v_lshlrev_b32 v22, 16, v47
    v_and_b32 v23, 0xffff0000, v47
    v_mul_f32 v24, 0xbfb8aa3b, v8
    v_mul_f32 v25, 0xbfb8aa3b, v9
    v_mul_f32 v26, 0xbfb8aa3b, v10
    v_mul_f32 v27, 0xbfb8aa3b, v11
    v_mul_f32 v28, 0xbfb8aa3b, v12
    v_mul_f32 v29, 0xbfb8aa3b, v13
    v_mul_f32 v30, 0xbfb8aa3b, v14
    v_mul_f32 v31, 0xbfb8aa3b, v15
    v_mul_f32 v32, 0xbfb8aa3b, v16
    v_mul_f32 v33, 0xbfb8aa3b, v17
    v_mul_f32 v34, 0xbfb8aa3b, v18
    v_mul_f32 v35, 0xbfb8aa3b, v19
    v_mul_f32 v36, 0xbfb8aa3b, v20
    v_mul_f32 v37, 0xbfb8aa3b, v21
    v_mul_f32 v38, 0xbfb8aa3b, v22
    v_mul_f32 v39, 0xbfb8aa3b, v23
    v_exp_f32 v24, v24
    v_exp_f32 v25, v25
    v_exp_f32 v26, v26
    v_exp_f32 v27, v27
    v_exp_f32 v28, v28
    v_exp_f32 v29, v29
    v_exp_f32 v30, v30
    v_exp_f32 v31, v31
    v_exp_f32 v32, v32
    v_exp_f32 v33, v33
    v_exp_f32 v34, v34
    v_exp_f32 v35, v35
    v_exp_f32 v36, v36
    v_exp_f32 v37, v37
    v_exp_f32 v38, v38
    v_exp_f32 v39, v39
    v_add_f32 v24, 1.0, v24
    v_add_f32 v25, 1.0, v25
    v_add_f32 v26, 1.0, v26
    v_add_f32 v27, 1.0, v27
    v_add_f32 v28, 1.0, v28
    v_add_f32 v29, 1.0, v29
    v_add_f32 v30, 1.0, v30
    v_add_f32 v31, 1.0, v31
    v_add_f32 v32, 1.0, v32
    v_add_f32 v33, 1.0, v33
    v_add_f32 v34, 1.0, v34
    v_add_f32 v35, 1.0, v35
    v_add_f32 v36, 1.0, v36
    v_add_f32 v37, 1.0, v37
    v_add_f32 v38, 1.0, v38
    v_add_f32 v39, 1.0, v39
    v_rcp_f32 v24, v24
    v_rcp_f32 v25, v25
    v_rcp_f32 v26, v26
    v_rcp_f32 v27, v27
    v_rcp_f32 v28, v28
    v_rcp_f32 v29, v29
    v_rcp_f32 v30, v30
    v_rcp_f32 v31, v31
    v_rcp_f32 v32, v32
    v_rcp_f32 v33, v33
    v_rcp_f32 v34, v34
    v_rcp_f32 v35, v35
    v_rcp_f32 v36, v36
    v_rcp_f32 v37, v37
    v_rcp_f32 v38, v38
    v_rcp_f32 v39, v39
    v_mul_f32 v8, v8, v24
    v_mul_f32 v9, v9, v25
    v_mul_f32 v10, v10, v26
    v_mul_f32 v11, v11, v27
    v_mul_f32 v12, v12, v28
    v_mul_f32 v13, v13, v29
    v_mul_f32 v14, v14, v30
    v_mul_f32 v15, v15, v31
    v_mul_f32 v16, v16, v32
    v_mul_f32 v17, v17, v33
    v_mul_f32 v18, v18, v34
    v_mul_f32 v19, v19, v35
    v_mul_f32 v20, v20, v36
    v_mul_f32 v21, v21, v37
    v_mul_f32 v22, v22, v38
    v_mul_f32 v23, v23, v39
    v_cvt_pk_bf16_f32 v240, v8, v9
    v_cvt_pk_bf16_f32 v241, v10, v11
    v_cvt_pk_bf16_f32 v242, v12, v13
    v_cvt_pk_bf16_f32 v243, v14, v15
    v_cvt_pk_bf16_f32 v244, v16, v17
    v_cvt_pk_bf16_f32 v245, v18, v19
    v_cvt_pk_bf16_f32 v246, v20, v21
    v_cvt_pk_bf16_f32 v247, v22, v23
    ds_write_b128 v4, v[240:243] offset:6144
    ds_write_b128 v4, v[244:247] offset:7168
    s_waitcnt lgkmcnt(0)
    s_barrier
    ds_read_b128 v[64:67], v1 offset:0
    ds_read_b128 v[68:71], v1 offset:1024
    ds_read_b128 v[72:75], v1 offset:2048
    ds_read_b128 v[76:79], v1 offset:3072
    ds_read_b128 v[80:83], v1 offset:4096
    ds_read_b128 v[84:87], v1 offset:5120
    ds_read_b128 v[88:91], v1 offset:6144
    ds_read_b128 v[92:95], v1 offset:7168
    s_waitcnt vmcnt(15) lgkmcnt(7)
    v_mfma_f32_32x32x16_bf16 v[192:207], v[128:131], v[64:67], 0
    buffer_load_dwordx4 v[128:131], v1, s[12:15], s24 offen offset:0
    ds_read_b128 v[64:67], v1 offset:8192
    s_waitcnt vmcnt(15) lgkmcnt(7)
    v_mfma_f32_32x32x16_bf16 v[192:207], v[132:135], v[68:71], v[192:207]
    buffer_load_dwordx4 v[132:135], v1, s[12:15], s24 offen offset:1024
    ds_read_b128 v[68:71], v1 offset:9216
    s_waitcnt vmcnt(15) lgkmcnt(7)
    v_mfma_f32_32x32x16_bf16 v[192:207], v[136:139], v[72:75], v[192:207]
    buffer_load_dwordx4 v[136:139], v1, s[12:15], s24 offen offset:2048
    ds_read_b128 v[72:75], v1 offset:10240
    s_waitcnt vmcnt(15) lgkmcnt(7)
    v_mfma_f32_32x32x16_bf16 v[192:207], v[140:143], v[76:79], v[192:207]
    buffer_load_dwordx4 v[140:143], v1, s[12:15], s24 offen offset:3072
    s_add_u32 s24, s24, 4096
    ds_read_b128 v[76:79], v1 offset:11264
    s_waitcnt vmcnt(15) lgkmcnt(7)
    v_mfma_f32_32x32x16_bf16 v[192:207], v[144:147], v[80:83], v[192:207]
    buffer_load_dwordx4 v[144:147], v1, s[12:15], s24 offen offset:0
    ds_read_b128 v[80:83], v1 offset:12288
    s_waitcnt vmcnt(15) lgkmcnt(7)
    v_mfma_f32_32x32x16_bf16 v[192:207], v[148:151], v[84:87], v[192:207]
    buffer_load_dwordx4 v[148:151], v1, s[12:15], s24 offen offset:1024
    ds_read_b128 v[84:87], v1 offset:13312
    s_waitcnt vmcnt(15) lgkmcnt(7)
    v_mfma_f32_32x32x16_bf16 v[192:207], v[152:155], v[88:91], v[192:207]
    buffer_load_dwordx4 v[152:155], v1, s[12:15], s24 offen offset:2048
    ds_read_b128 v[88:91], v1 offset:14336
    s_waitcnt vmcnt(15) lgkmcnt(7)
    v_mfma_f32_32x32x16_bf16 v[192:207], v[156:159], v[92:95], v[192:207]
    buffer_load_dwordx4 v[156:159], v1, s[12:15], s24 offen offset:3072
    s_add_u32 s24, s24, 4096
    ds_read_b128 v[92:95], v1 offset:15360
    s_waitcnt vmcnt(15) lgkmcnt(7)
    v_mfma_f32_32x32x16_bf16 v[192:207], v[160:163], v[64:67], v[192:207]
    buffer_load_dwordx4 v[160:163], v1, s[12:15], s24 offen offset:0
    ds_read_b128 v[64:67], v1 offset:16384
    s_waitcnt vmcnt(15) lgkmcnt(7)
    v_mfma_f32_32x32x16_bf16 v[192:207], v[164:167], v[68:71], v[192:207]
    buffer_load_dwordx4 v[164:167], v1, s[12:15], s24 offen offset:1024
    ds_read_b128 v[68:71], v1 offset:17408
    s_waitcnt vmcnt(15) lgkmcnt(7)
    v_mfma_f32_32x32x16_bf16 v[192:207], v[168:171], v[72:75], v[192:207]
    buffer_load_dwordx4 v[168:171], v1, s[12:15], s24 offen offset:2048
    ds_read_b128 v[72:75], v1 offset:18432
    s_waitcnt vmcnt(15) lgkmcnt(7)
    v_mfma_f32_32x32x16_bf16 v[192:207], v[172:175], v[76:79], v[192:207]
    buffer_load_dwordx4 v[172:175], v1, s[12:15], s24 offen offset:3072
    s_add_u32 s24, s24, 4096
    ds_read_b128 v[76:79], v1 offset:19456
    s_waitcnt vmcnt(15) lgkmcnt(7)
    v_mfma_f32_32x32x16_bf16 v[192:207], v[176:179], v[80:83], v[192:207]
    buffer_load_dwordx4 v[176:179], v1, s[12:15], s24 offen offset:0
    ds_read_b128 v[80:83], v1 offset:20480
    s_waitcnt vmcnt(15) lgkmcnt(7)
    v_mfma_f32_32x32x16_bf16 v[192:207], v[180:183], v[84:87], v[192:207]
    buffer_load_dwordx4 v[180:183], v1, s[12:15], s24 offen offset:1024
    ds_read_b128 v[84:87], v1 offset:21504
    s_waitcnt vmcnt(15) lgkmcnt(7)
    v_mfma_f32_32x32x16_bf16 v[192:207], v[184:187], v[88:91], v[192:207]
    buffer_load_dwordx4 v[184:187], v1, s[12:15], s24 offen offset:2048
    ds_read_b128 v[88:91], v1 offset:22528
    s_waitcnt vmcnt(15) lgkmcnt(7)
    v_mfma_f32_32x32x16_bf16 v[192:207], v[188:191], v[92:95], v[192:207]
    buffer_load_dwordx4 v[188:191], v1, s[12:15], s24 offen offset:3072
    s_add_u32 s24, s24, 4096
    ds_read_b128 v[92:95], v1 offset:23552
    s_waitcnt vmcnt(15) lgkmcnt(7)
    v_mfma_f32_32x32x16_bf16 v[192:207], v[128:131], v[64:67], v[192:207]
    buffer_load_dwordx4 v[128:131], v1, s[12:15], s24 offen offset:0
    ds_read_b128 v[64:67], v1 offset:24576
    s_waitcnt vmcnt(15) lgkmcnt(7)
    v_mfma_f32_32x32x16_bf16 v[192:207], v[132:135], v[68:71], v[192:207]
    buffer_load_dwordx4 v[132:135], v1, s[12:15], s24 offen offset:1024
    ds_read_b128 v[68:71], v1 offset:25600
    s_waitcnt vmcnt(15) lgkmcnt(7)
    v_mfma_f32_32x32x16_bf16 v[192:207], v[136:139], v[72:75], v[192:207]
    buffer_load_dwordx4 v[136:139], v1, s[12:15], s24 offen offset:2048
    ds_read_b128 v[72:75], v1 offset:26624
    s_waitcnt vmcnt(15) lgkmcnt(7)
    v_mfma_f32_32x32x16_bf16 v[192:207], v[140:143], v[76:79], v[192:207]
    buffer_load_dwordx4 v[140:143], v1, s[12:15], s24 offen offset:3072
    s_add_u32 s24, s24, 4096
    ds_read_b128 v[76:79], v1 offset:27648
    s_waitcnt vmcnt(15) lgkmcnt(7)
    v_mfma_f32_32x32x16_bf16 v[192:207], v[144:147], v[80:83], v[192:207]
    buffer_load_dwordx4 v[144:147], v1, s[12:15], s24 offen offset:0
    ds_read_b128 v[80:83], v1 offset:28672
    s_waitcnt vmcnt(15) lgkmcnt(7)
    v_mfma_f32_32x32x16_bf16 v[192:207], v[148:151], v[84:87], v[192:207]
    buffer_load_dwordx4 v[148:151], v1, s[12:15], s24 offen offset:1024
    ds_read_b128 v[84:87], v1 offset:29696
    s_waitcnt vmcnt(15) lgkmcnt(7)
    v_mfma_f32_32x32x16_bf16 v[192:207], v[152:155], v[88:91], v[192:207]
    buffer_load_dwordx4 v[152:155], v1, s[12:15], s24 offen offset:2048
    ds_read_b128 v[88:91], v1 offset:30720
    s_waitcnt vmcnt(15) lgkmcnt(7)
    v_mfma_f32_32x32x16_bf16 v[192:207], v[156:159], v[92:95], v[192:207]
    buffer_load_dwordx4 v[156:159], v1, s[12:15], s24 offen offset:3072
    s_add_u32 s24, s24, 4096
    ds_read_b128 v[92:95], v1 offset:31744
    s_waitcnt vmcnt(15) lgkmcnt(7)
    v_mfma_f32_32x32x16_bf16 v[192:207], v[160:163], v[64:67], v[192:207]
    buffer_load_dwordx4 v[160:163], v1, s[12:15], s24 offen offset:0
    ds_read_b128 v[64:67], v1 offset:32768
    s_waitcnt vmcnt(15) lgkmcnt(7)
    v_mfma_f32_32x32x16_bf16 v[192:207], v[164:167], v[68:71], v[192:207]
    buffer_load_dwordx4 v[164:167], v1, s[12:15], s24 offen offset:1024
    ds_read_b128 v[68:71], v1 offset:33792
    s_waitcnt vmcnt(15) lgkmcnt(7)
    v_mfma_f32_32x32x16_bf16 v[192:207], v[168:171], v[72:75], v[192:207]
    buffer_load_dwordx4 v[168:171], v1, s[12:15], s24 offen offset:2048
    ds_read_b128 v[72:75], v1 offset:34816
    s_waitcnt vmcnt(15) lgkmcnt(7)
    v_mfma_f32_32x32x16_bf16 v[192:207], v[172:175], v[76:79], v[192:207]
    buffer_load_dwordx4 v[172:175], v1, s[12:15], s24 offen offset:3072
    s_add_u32 s24, s24, 4096
    ds_read_b128 v[76:79], v1 offset:35840
    s_waitcnt vmcnt(15) lgkmcnt(7)
    v_mfma_f32_32x32x16_bf16 v[192:207], v[176:179], v[80:83], v[192:207]
    buffer_load_dwordx4 v[176:179], v1, s[12:15], s24 offen offset:0
    ds_read_b128 v[80:83], v1 offset:36864
    s_waitcnt vmcnt(15) lgkmcnt(7)
    v_mfma_f32_32x32x16_bf16 v[192:207], v[180:183], v[84:87], v[192:207]
    buffer_load_dwordx4 v[180:183], v1, s[12:15], s24 offen offset:1024
    ds_read_b128 v[84:87], v1 offset:37888
    s_waitcnt vmcnt(15) lgkmcnt(7)
    v_mfma_f32_32x32x16_bf16 v[192:207], v[184:187], v[88:91], v[192:207]
    buffer_load_dwordx4 v[184:187], v1, s[12:15], s24 offen offset:2048
    ds_read_b128 v[88:91], v1 offset:38912
    s_waitcnt vmcnt(15) lgkmcnt(7)
    v_mfma_f32_32x32x16_bf16 v[192:207], v[188:191], v[92:95], v[192:207]
    buffer_load_dwordx4 v[188:191], v1, s[12:15], s24 offen offset:3072
    s_add_u32 s24, s24, 4096
    ds_read_b128 v[92:95], v1 offset:39936
    s_waitcnt vmcnt(15) lgkmcnt(7)
    v_mfma_f32_32x32x16_bf16 v[192:207], v[128:131], v[64:67], v[192:207]
    buffer_load_dwordx4 v[128:131], v1, s[12:15], s24 offen offset:0
    ds_read_b128 v[64:67], v1 offset:40960
    s_waitcnt vmcnt(15) lgkmcnt(7)
    v_mfma_f32_32x32x16_bf16 v[192:207], v[132:135], v[68:71], v[192:207]
    buffer_load_dwordx4 v[132:135], v1, s[12:15], s24 offen offset:1024
    ds_read_b128 v[68:71], v1 offset:41984
    s_waitcnt vmcnt(15) lgkmcnt(7)
    v_mfma_f32_32x32x16_bf16 v[192:207], v[136:139], v[72:75], v[192:207]
    buffer_load_dwordx4 v[136:139], v1, s[12:15], s24 offen offset:2048
    ds_read_b128 v[72:75], v1 offset:43008
    s_waitcnt vmcnt(15) lgkmcnt(7)
    v_mfma_f32_32x32x16_bf16 v[192:207], v[140:143], v[76:79], v[192:207]
    buffer_load_dwordx4 v[140:143], v1, s[12:15], s24 offen offset:3072
    s_add_u32 s24, s24, 4096
    ds_read_b128 v[76:79], v1 offset:44032
    s_waitcnt vmcnt(15) lgkmcnt(7)
    v_mfma_f32_32x32x16_bf16 v[192:207], v[144:147], v[80:83], v[192:207]
    buffer_load_dwordx4 v[144:147], v1, s[12:15], s24 offen offset:0
    ds_read_b128 v[80:83], v1 offset:45056
    s_waitcnt vmcnt(15) lgkmcnt(7)
    v_mfma_f32_32x32x16_bf16 v[192:207], v[148:151], v[84:87], v[192:207]
    buffer_load_dwordx4 v[148:151], v1, s[12:15], s24 offen offset:1024
    ds_read_b128 v[84:87], v1 offset:46080
    s_waitcnt vmcnt(15) lgkmcnt(7)
    v_mfma_f32_32x32x16_bf16 v[192:207], v[152:155], v[88:91], v[192:207]
    buffer_load_dwordx4 v[152:155], v1, s[12:15], s24 offen offset:2048
    ds_read_b128 v[88:91], v1 offset:47104
    s_waitcnt vmcnt(15) lgkmcnt(7)
    v_mfma_f32_32x32x16_bf16 v[192:207], v[156:159], v[92:95], v[192:207]
    buffer_load_dwordx4 v[156:159], v1, s[12:15], s24 offen offset:3072
    s_add_u32 s24, s24, 4096
    ds_read_b128 v[92:95], v1 offset:48128
    s_waitcnt vmcnt(15) lgkmcnt(7)
    v_mfma_f32_32x32x16_bf16 v[192:207], v[160:163], v[64:67], v[192:207]
    buffer_load_dwordx4 v[160:163], v1, s[12:15], s24 offen offset:0
    ds_read_b128 v[64:67], v1 offset:49152
    s_waitcnt vmcnt(15) lgkmcnt(7)
    v_mfma_f32_32x32x16_bf16 v[192:207], v[164:167], v[68:71], v[192:207]
    buffer_load_dwordx4 v[164:167], v1, s[12:15], s24 offen offset:1024
    ds_read_b128 v[68:71], v1 offset:50176
    s_waitcnt vmcnt(15) lgkmcnt(7)
    v_mfma_f32_32x32x16_bf16 v[192:207], v[168:171], v[72:75], v[192:207]
    buffer_load_dwordx4 v[168:171], v1, s[12:15], s24 offen offset:2048
    ds_read_b128 v[72:75], v1 offset:51200
    s_waitcnt vmcnt(15) lgkmcnt(7)
    v_mfma_f32_32x32x16_bf16 v[192:207], v[172:175], v[76:79], v[192:207]
    buffer_load_dwordx4 v[172:175], v1, s[12:15], s24 offen offset:3072
    s_add_u32 s24, s24, 4096
    ds_read_b128 v[76:79], v1 offset:52224
    s_waitcnt vmcnt(15) lgkmcnt(7)
    v_mfma_f32_32x32x16_bf16 v[192:207], v[176:179], v[80:83], v[192:207]
    buffer_load_dwordx4 v[176:179], v1, s[12:15], s24 offen offset:0
    ds_read_b128 v[80:83], v1 offset:53248
    s_waitcnt vmcnt(15) lgkmcnt(7)
    v_mfma_f32_32x32x16_bf16 v[192:207], v[180:183], v[84:87], v[192:207]
    buffer_load_dwordx4 v[180:183], v1, s[12:15], s24 offen offset:1024
    ds_read_b128 v[84:87], v1 offset:54272
    s_waitcnt vmcnt(15) lgkmcnt(7)
    v_mfma_f32_32x32x16_bf16 v[192:207], v[184:187], v[88:91], v[192:207]
    buffer_load_dwordx4 v[184:187], v1, s[12:15], s24 offen offset:2048
    ds_read_b128 v[88:91], v1 offset:55296
    s_waitcnt vmcnt(15) lgkmcnt(7)
    v_mfma_f32_32x32x16_bf16 v[192:207], v[188:191], v[92:95], v[192:207]
    buffer_load_dwordx4 v[188:191], v1, s[12:15], s24 offen offset:3072
    s_add_u32 s24, s24, 4096
    ds_read_b128 v[92:95], v1 offset:56320
    s_waitcnt vmcnt(15) lgkmcnt(7)
    v_mfma_f32_32x32x16_bf16 v[192:207], v[128:131], v[64:67], v[192:207]
    ds_read_b128 v[64:67], v1 offset:57344
    s_waitcnt vmcnt(14) lgkmcnt(7)
    v_mfma_f32_32x32x16_bf16 v[192:207], v[132:135], v[68:71], v[192:207]
    ds_read_b128 v[68:71], v1 offset:58368
    s_waitcnt vmcnt(13) lgkmcnt(7)
    v_mfma_f32_32x32x16_bf16 v[192:207], v[136:139], v[72:75], v[192:207]
    ds_read_b128 v[72:75], v1 offset:59392
    s_waitcnt vmcnt(12) lgkmcnt(7)
    v_mfma_f32_32x32x16_bf16 v[192:207], v[140:143], v[76:79], v[192:207]
    ds_read_b128 v[76:79], v1 offset:60416
    s_waitcnt vmcnt(11) lgkmcnt(7)
    v_mfma_f32_32x32x16_bf16 v[192:207], v[144:147], v[80:83], v[192:207]
    ds_read_b128 v[80:83], v1 offset:61440
    s_waitcnt vmcnt(10) lgkmcnt(7)
    v_mfma_f32_32x32x16_bf16 v[192:207], v[148:151], v[84:87], v[192:207]
    ds_read_b128 v[84:87], v1 offset:62464
    s_waitcnt vmcnt(9) lgkmcnt(7)
    v_mfma_f32_32x32x16_bf16 v[192:207], v[152:155], v[88:91], v[192:207]
    ds_read_b128 v[88:91], v1 offset:63488
    s_waitcnt vmcnt(8) lgkmcnt(7)
    v_mfma_f32_32x32x16_bf16 v[192:207], v[156:159], v[92:95], v[192:207]
    ds_read_b128 v[92:95], v1 offset:64512
    s_waitcnt vmcnt(7) lgkmcnt(7)
    v_mfma_f32_32x32x16_bf16 v[192:207], v[160:163], v[64:67], v[192:207]
    s_waitcnt vmcnt(6) lgkmcnt(6)
    v_mfma_f32_32x32x16_bf16 v[192:207], v[164:167], v[68:71], v[192:207]
    s_waitcnt vmcnt(5) lgkmcnt(5)
    v_mfma_f32_32x32x16_bf16 v[192:207], v[168:171], v[72:75], v[192:207]
    s_waitcnt vmcnt(4) lgkmcnt(4)
    v_mfma_f32_32x32x16_bf16 v[192:207], v[172:175], v[76:79], v[192:207]
    s_waitcnt vmcnt(3) lgkmcnt(3)
    v_mfma_f32_32x32x16_bf16 v[192:207], v[176:179], v[80:83], v[192:207]
    s_waitcnt vmcnt(2) lgkmcnt(2)
    v_mfma_f32_32x32x16_bf16 v[192:207], v[180:183], v[84:87], v[192:207]
    s_waitcnt vmcnt(1) lgkmcnt(1)
    v_mfma_f32_32x32x16_bf16 v[192:207], v[184:187], v[88:91], v[192:207]
    s_waitcnt vmcnt(0) lgkmcnt(0)
    v_mfma_f32_32x32x16_bf16 v[192:207], v[188:191], v[92:95], v[192:207]
    s_nop 11
    v_fma_f32 v8, v192, 0.5, v224
    v_fma_f32 v9, v193, 0.5, v225
    v_fma_f32 v10, v194, 0.5, v226
    v_fma_f32 v11, v195, 0.5, v227
    v_fma_f32 v12, v196, 0.5, v228
    v_fma_f32 v13, v197, 0.5, v229
    v_fma_f32 v14, v198, 0.5, v230
    v_fma_f32 v15, v199, 0.5, v231
    v_fma_f32 v16, v200, 0.5, v232
    v_fma_f32 v17, v201, 0.5, v233
    v_fma_f32 v18, v202, 0.5, v234
    v_fma_f32 v19, v203, 0.5, v235
    v_fma_f32 v20, v204, 0.5, v236
    v_fma_f32 v21, v205, 0.5, v237
    v_fma_f32 v22, v206, 0.5, v238
    v_fma_f32 v23, v207, 0.5, v239
    v_cvt_pk_bf16_f32 v240, v8, v9
    v_cvt_pk_bf16_f32 v241, v10, v11
    v_cvt_pk_bf16_f32 v242, v12, v13
    v_cvt_pk_bf16_f32 v243, v14, v15
    v_cvt_pk_bf16_f32 v244, v16, v17
    v_cvt_pk_bf16_f32 v245, v18, v19
    v_cvt_pk_bf16_f32 v246, v20, v21
    v_cvt_pk_bf16_f32 v247, v22, v23
    v_lshlrev_b32 v224, 16, v240
    v_and_b32 v225, 0xffff0000, v240
    v_lshlrev_b32 v226, 16, v241
    v_and_b32 v227, 0xffff0000, v241
    v_lshlrev_b32 v228, 16, v242
    v_and_b32 v229, 0xffff0000, v242
    v_lshlrev_b32 v230, 16, v243
    v_and_b32 v231, 0xffff0000, v243
    v_lshlrev_b32 v232, 16, v244
    v_and_b32 v233, 0xffff0000, v244
    v_lshlrev_b32 v234, 16, v245
    v_and_b32 v235, 0xffff0000, v245
    v_lshlrev_b32 v236, 16, v246
    v_and_b32 v237, 0xffff0000, v246
    v_lshlrev_b32 v238, 16, v247
    v_and_b32 v239, 0xffff0000, v247
    v_add_f32 v8, v224, v225
    v_add_f32 v9, v226, v227
    v_add_f32 v8, v8, v228
    v_add_f32 v9, v9, v229
    v_add_f32 v8, v8, v230
    v_add_f32 v9, v9, v231
    v_add_f32 v8, v8, v232
    v_add_f32 v9, v9, v233
    v_add_f32 v8, v8, v234
    v_add_f32 v9, v9, v235
    v_add_f32 v8, v8, v236
    v_add_f32 v9, v9, v237
    v_add_f32 v8, v8, v238
    v_add_f32 v9, v9, v239
    v_add_f32 v8, v8, v9
    v_mul_f32 v8, 0x3d800000, v8
    v_sub_f32 v10, v224, v8
    v_mul_f32 v14, v10, v10
    v_sub_f32 v11, v225, v8
    v_mul_f32 v15, v11, v11
    v_sub_f32 v12, v226, v8
    v_fma_f32 v14, v12, v12, v14
    v_sub_f32 v13, v227, v8
    v_fma_f32 v15, v13, v13, v15
    v_sub_f32 v10, v228, v8
    v_fma_f32 v14, v10, v10, v14
    v_sub_f32 v11, v229, v8
    v_fma_f32 v15, v11, v11, v15
    v_sub_f32 v12, v230, v8
    v_fma_f32 v14, v12, v12, v14
    v_sub_f32 v13, v231, v8
    v_fma_f32 v15, v13, v13, v15
    v_sub_f32 v10, v232, v8
    v_fma_f32 v14, v10, v10, v14
    v_sub_f32 v11, v233, v8
    v_fma_f32 v15, v11, v11, v15
    v_sub_f32 v12, v234, v8
    v_fma_f32 v14, v12, v12, v14
    v_sub_f32 v13, v235, v8
    v_fma_f32 v15, v13, v13, v15
    v_sub_f32 v10, v236, v8
    v_fma_f32 v14, v10, v10, v14
    v_sub_f32 v11, v237, v8
    v_fma_f32 v15, v11, v11, v15
    v_sub_f32 v12, v238, v8
    v_fma_f32 v14, v12, v12, v14
    v_sub_f32 v13, v239, v8
    v_fma_f32 v15, v13, v13, v15
    v_add_f32 v9, v14, v15
    ds_write_b64 v5, v[8:9] offset:0
    s_waitcnt lgkmcnt(0)
    s_barrier
    ds_read_b128 v[64:67], v6 offset:0
    ds_read_b128 v[68:71], v6 offset:16
    ds_read_b128 v[72:75], v6 offset:32
    ds_read_b128 v[76:79], v6 offset:48
    ds_read_b128 v[80:83], v6 offset:64
    ds_read_b128 v[84:87], v6 offset:80
    ds_read_b128 v[88:91], v6 offset:96
    ds_read_b128 v[92:95], v6 offset:112
    s_waitcnt lgkmcnt(7)
    v_add_f32 v8, v64, v66
    s_waitcnt lgkmcnt(6)
    v_add_f32 v9, v68, v70
    s_waitcnt lgkmcnt(5)
    v_add_f32 v8, v8, v72
    v_add_f32 v9, v9, v74
    s_waitcnt lgkmcnt(4)
    v_add_f32 v8, v8, v76
    v_add_f32 v9, v9, v78
    s_waitcnt lgkmcnt(3)
    v_add_f32 v8, v8, v80
    v_add_f32 v9, v9, v82
    s_waitcnt lgkmcnt(2)
    v_add_f32 v8, v8, v84
    v_add_f32 v9, v9, v86
    s_waitcnt lgkmcnt(1)
    v_add_f32 v8, v8, v88
    v_add_f32 v9, v9, v90
    s_waitcnt lgkmcnt(0)
    v_add_f32 v8, v8, v92
    v_add_f32 v9, v9, v94
    v_add_f32 v8, v8, v9
    v_mul_f32 v8, 0x3d800000, v8
    v_add_f32 v9, v65, v67
    v_add_f32 v10, v69, v71
    v_add_f32 v9, v9, v73
    v_add_f32 v10, v10, v75
    v_add_f32 v9, v9, v77
    v_add_f32 v10, v10, v79
    v_add_f32 v9, v9, v81
    v_add_f32 v10, v10, v83
    v_add_f32 v9, v9, v85
    v_add_f32 v10, v10, v87
    v_add_f32 v9, v9, v89
    v_add_f32 v10, v10, v91
    v_add_f32 v9, v9, v93
    v_add_f32 v10, v10, v95
    v_add_f32 v9, v9, v10
    v_sub_f32 v12, v64, v8
    v_mul_f32 v10, v12, v12
    v_sub_f32 v13, v66, v8
    v_mul_f32 v11, v13, v13
    v_sub_f32 v14, v68, v8
    v_fma_f32 v10, v14, v14, v10
    v_sub_f32 v15, v70, v8
    v_fma_f32 v11, v15, v15, v11
    v_sub_f32 v12, v72, v8
    v_fma_f32 v10, v12, v12, v10
    v_sub_f32 v13, v74, v8
    v_fma_f32 v11, v13, v13, v11
    v_sub_f32 v14, v76, v8
    v_fma_f32 v10, v14, v14, v10
    v_sub_f32 v15, v78, v8
    v_fma_f32 v11, v15, v15, v11
    v_sub_f32 v12, v80, v8
    v_fma_f32 v10, v12, v12, v10
    v_sub_f32 v13, v82, v8
    v_fma_f32 v11, v13, v13, v11
    v_sub_f32 v14, v84, v8
    v_fma_f32 v10, v14, v14, v10
    v_sub_f32 v15, v86, v8
    v_fma_f32 v11, v15, v15, v11
    v_sub_f32 v12, v88, v8
    v_fma_f32 v10, v12, v12, v10
    v_sub_f32 v13, v90, v8
    v_fma_f32 v11, v13, v13, v11
    v_sub_f32 v14, v92, v8
    v_fma_f32 v10, v14, v14, v10
    v_sub_f32 v15, v94, v8
    v_fma_f32 v11, v15, v15, v11
    v_add_f32 v10, v10, v11
    v_mov_b32 v11, 0x41800000
    v_fma_f32 v9, v10, v11, v9
    v_mul_f32 v9, 0x3b800000, v9
    v_cvt_pk_bf16_f32 v10, v8, v9
    v_lshlrev_b32 v8, 16, v10
    v_and_b32 v9, 0xffff0000, v10
    v_add_f32 v9, 0x3727c5ac, v9
    v_cvt_pk_bf16_f32 v9, v9, v9
    v_lshlrev_b32 v9, 16, v9
    v_sqrt_f32 v9, v9
    s_nop 0
    v_cvt_pk_bf16_f32 v9, v9, v9
    v_lshlrev_b32 v9, 16, v9
    v_rcp_f32 v9, v9
    v_sub_f32 v10, v224, v8
    v_sub_f32 v11, v225, v8
    v_sub_f32 v12, v226, v8
    v_sub_f32 v13, v227, v8
    v_sub_f32 v14, v228, v8
    v_sub_f32 v15, v229, v8
    v_sub_f32 v16, v230, v8
    v_sub_f32 v17, v231, v8
    v_sub_f32 v18, v232, v8
    v_sub_f32 v19, v233, v8
    v_sub_f32 v20, v234, v8
    v_sub_f32 v21, v235, v8
    v_sub_f32 v22, v236, v8
    v_sub_f32 v23, v237, v8
    v_sub_f32 v24, v238, v8
    v_sub_f32 v25, v239, v8
    v_mul_f32 v10, v10, v9
    v_mul_f32 v11, v11, v9
    v_mul_f32 v12, v12, v9
    v_mul_f32 v13, v13, v9
    v_mul_f32 v14, v14, v9
    v_mul_f32 v15, v15, v9
    v_mul_f32 v16, v16, v9
    v_mul_f32 v17, v17, v9
    v_mul_f32 v18, v18, v9
    v_mul_f32 v19, v19, v9
    v_mul_f32 v20, v20, v9
    v_mul_f32 v21, v21, v9
    v_mul_f32 v22, v22, v9
    v_mul_f32 v23, v23, v9
    v_mul_f32 v24, v24, v9
    v_mul_f32 v25, v25, v9
    v_cvt_pk_bf16_f32 v240, v10, v11
    v_cvt_pk_bf16_f32 v241, v12, v13
    v_cvt_pk_bf16_f32 v242, v14, v15
    v_cvt_pk_bf16_f32 v243, v16, v17
    v_cvt_pk_bf16_f32 v244, v18, v19
    v_cvt_pk_bf16_f32 v245, v20, v21
    v_cvt_pk_bf16_f32 v246, v22, v23
    v_cvt_pk_bf16_f32 v247, v24, v25
    s_lshl_b32 s25, s29, 14
    s_lshl_b32 s26, s3, 6
    s_add_u32 s25, s25, s26
    buffer_store_dwordx2 v[240:241], v7, s[16:19], s25 offen offset:0
    buffer_store_dwordx2 v[242:243], v7, s[16:19], s25 offen offset:16
    buffer_store_dwordx2 v[244:245], v7, s[16:19], s25 offen offset:32
    buffer_store_dwordx2 v[246:247], v7, s[16:19], s25 offen offset:48
L_exit_k3_kernel:
    s_endpgm
.section .rodata,"a"
.p2align 6
.amdhsa_kernel k0_kernel
  .amdhsa_next_free_vgpr 32
  .amdhsa_next_free_sgpr 102
  .amdhsa_accum_offset 32
  .amdhsa_group_segment_fixed_size 0
  .amdhsa_kernarg_size 104
  .amdhsa_user_sgpr_count 2
  .amdhsa_user_sgpr_kernarg_segment_ptr 1
  .amdhsa_system_sgpr_workgroup_id_x 1
.end_amdhsa_kernel
.p2align 6
.amdhsa_kernel k1_kernel
  .amdhsa_next_free_vgpr 256
  .amdhsa_next_free_sgpr 102
  .amdhsa_accum_offset 256
  .amdhsa_group_segment_fixed_size 0
  .amdhsa_kernarg_size 104
  .amdhsa_user_sgpr_count 2
  .amdhsa_user_sgpr_kernarg_segment_ptr 1
  .amdhsa_system_sgpr_workgroup_id_x 1
.end_amdhsa_kernel
.p2align 6
.amdhsa_kernel k2_kernel
  .amdhsa_next_free_vgpr 256
  .amdhsa_next_free_sgpr 102
  .amdhsa_accum_offset 256
  .amdhsa_group_segment_fixed_size 0
  .amdhsa_kernarg_size 104
  .amdhsa_user_sgpr_count 2
  .amdhsa_user_sgpr_kernarg_segment_ptr 1
  .amdhsa_system_sgpr_workgroup_id_x 1
.end_amdhsa_kernel
.p2align 6
.amdhsa_kernel k3_kernel
  .amdhsa_next_free_vgpr 256
  .amdhsa_next_free_sgpr 102
  .amdhsa_accum_offset 256
  .amdhsa_group_segment_fixed_size 0
  .amdhsa_kernarg_size 104
  .amdhsa_user_sgpr_count 2
  .amdhsa_user_sgpr_kernarg_segment_ptr 1
  .amdhsa_system_sgpr_workgroup_id_x 1
.end_amdhsa_kernel
```
